```python
import torch

def _softmax(x, axis=-1):
    return torch.softmax(x, dim=axis)
def _gelu(x):
    return torch.nn.functional.gelu(x, approximate="tanh")
def _silu(x):
    return torch.nn.functional.silu(x)
def _sigmoid(x):
    return torch.sigmoid(x)
def _layernorm(x, axis=-1, eps=1e-5):
    m = x.mean(dim=axis, keepdim=True)
    v = x.var(dim=axis, keepdim=True, unbiased=False)
    return (x - m) / torch.sqrt(v + eps)
def _scatter_add(tgt, idx, src, axis=0):
    return tgt.clone().index_add_(axis, idx, src)
def _segment_sum(src, seg, n):
    out = torch.zeros((n,) + src.shape[1:], dtype=src.dtype)
    return out.index_add_(0, seg, src)
def _pad(x, pw):
    flat = tuple(v for pair in reversed(pw) for v in pair)
    return torch.nn.functional.pad(x, flat)

kernel_name = 'parallel_sum__ssm_conv_s5__glu_gated_bilinear__prompt'

def setup_inputs():

    _w = (lambda a: (lambda t: t.to(torch.bfloat16) if t.is_floating_point() else t)(torch.as_tensor(a)))
    def _A_setup():
        B, S, D = 1, 2048, 512
        P = D
        Lambda_re = -0.5 * (lambda _x: torch.exp(torch.as_tensor(_x)))((lambda *s: torch.randn(*s, dtype=torch.bfloat16) * 0.2)(P))
        Lambda_im = (lambda *s: torch.randn(*s, dtype=torch.bfloat16) * 0.8)(P) * 1.0
        B_re = (lambda *s: torch.randn(*s, dtype=torch.bfloat16) * 0.2)(P, D) * (D ** -0.5)
        B_im = (lambda *s: torch.randn(*s, dtype=torch.bfloat16) * 0.2)(P, D) * (D ** -0.5)
        C_re = (lambda *s: torch.randn(*s, dtype=torch.bfloat16) * 0.2)(D, P) * (P ** -0.5)
        C_im = (lambda *s: torch.randn(*s, dtype=torch.bfloat16) * 0.2)(D, P) * (P ** -0.5)
        log_dt = (lambda *s: torch.randn(*s, dtype=torch.bfloat16) * 0.2)(P) * 0.3 - 2.0
        Dskip = (lambda *s: torch.randn(*s, dtype=torch.bfloat16) * 0.05)(D)
        return {
            "x": _w((lambda *s: torch.randn(*s, dtype=torch.bfloat16) * 0.05)(B, S, D)),
            "Lambda_re": _w(Lambda_re),
            "Lambda_im": _w(Lambda_im),
            "B_re": _w(B_re),
            "B_im": _w(B_im),
            "C_re": _w(C_re),
            "C_im": _w(C_im),
            "log_dt": _w(log_dt),
            "Dskip": _w(Dskip),
        }
    _A_in = _A_setup()

    def _B_setup():
        B, S, D, F = 1, 2048, 512, 1376
        return {
            "x": _w((lambda *s: torch.randn(*s, dtype=torch.bfloat16) * 0.05)(B, S, D)),
            "w_gate": _w((lambda *s: torch.randn(*s, dtype=torch.bfloat16) * 0.4)(D, F) * (D ** -0.5)),
            "w_up": _w((lambda *s: torch.randn(*s, dtype=torch.bfloat16) * 0.4)(D, F) * (D ** -0.5)),
            "w_down": _w((lambda *s: torch.randn(*s, dtype=torch.bfloat16) * 0.4)(F, D) * (F ** -0.5)),
        }
    _B_in = _B_setup()

    return {
        "A_x": _A_in["x"],
        "A_Lambda_re": _A_in["Lambda_re"],
        "A_Lambda_im": _A_in["Lambda_im"],
        "A_B_re": _A_in["B_re"],
        "A_B_im": _A_in["B_im"],
        "A_C_re": _A_in["C_re"],
        "A_C_im": _A_in["C_im"],
        "A_log_dt": _A_in["log_dt"],
        "A_Dskip": _A_in["Dskip"],
        "B_x": _B_in["x"],
        "B_w_gate": _B_in["w_gate"],
        "B_w_up": _B_in["w_up"],
        "B_w_down": _B_in["w_down"],
    }

def reference(A_x, A_Lambda_re, A_Lambda_im, A_B_re, A_B_im, A_C_re, A_C_im, A_log_dt, A_Dskip, B_x, B_w_gate, B_w_up, B_w_down):
    def _A_ref(x, Lambda_re, Lambda_im, B_re, B_im, C_re, C_im, log_dt, Dskip):
        Bsz, L, H = x.shape
        Lam = Lambda_re + 1j * Lambda_im
        Bmat = B_re + 1j * B_im
        Cmat = C_re + 1j * C_im
        dt = torch.exp(log_dt)
        Lam_bar = torch.exp(dt * Lam)
        B_bar = ((Lam_bar - 1.0) / Lam)[:, None] * Bmat
        Bu = torch.einsum("bld,pd->blp", x + 0j, B_bar)
        h = torch.zeros_like(Bu[:, 0, :])
        hs = []
        for t in range(L):
            h = Lam_bar[None, :] * h + Bu[:, t, :]
            hs.append(h)
        hseq = torch.stack(hs, 1)
        y = 2.0 * torch.einsum("blp,dp->bld", hseq, Cmat).real + x * Dskip[None, None, :]
        return y

    def _B_ref(x, w_gate, w_up, w_down):
        g = torch.einsum("bsd,df->bsf", x, w_gate)
        u = torch.einsum("bsd,df->bsf", x, w_up)
        h = g * u
        return torch.einsum("bsf,fd->bsd", h, w_down)

    x = A_x
    xn = _layernorm(x, axis=-1)
    return x + _A_ref(xn, A_Lambda_re, A_Lambda_im, A_B_re, A_B_im, A_C_re, A_C_im, A_log_dt, A_Dskip) + _B_ref(xn, B_w_gate, B_w_up, B_w_down)
```

```asm
; @launch grid=(256,1,1) block=(256,1,1) lds=163840
.amdgcn_target "amdgcn-amd-amdhsa--gfx950"
.text
.globl parallel_sum__ssm_conv_s5__glu_gated_bilinear__prompt_kernel
.p2align 8
.type parallel_sum__ssm_conv_s5__glu_gated_bilinear__prompt_kernel,@function
parallel_sum__ssm_conv_s5__glu_gated_bilinear__prompt_kernel:
    s_cmp_ge_u32 s2, 256
    s_cbranch_scc1 parallel_sum__ssm_conv_s5__glu_gated_bilinear__prompt_kernel_done
    s_load_dwordx16 s[4:19], s[0:1], 0
    s_load_dwordx16 s[20:35], s[0:1], 64
    s_getpc_b64 s[76:77]
    v_lshrrev_b32 v5, 6, v0
    v_and_b32 v1, 63, v0
    s_and_b32 s3, s2, 7
    v_readfirstlane_b32 s60, v5
    s_lshr_b32 s63, s2, 3
    s_mul_i32 s64, s63, 640
    v_min_u32 v2, 4, v0
    v_lshl_add_u32 v2, v2, 7, s64
    global_load_dword v168, v2, s[76:77]
    s_and_b32 s61, s3, 1
    s_lshl_b32 s61, s61, 3
    s_and_b32 s64, s63, 7
    s_add_u32 s61, s61, s64
    s_lshr_b32 s62, s3, 1
    s_lshl_b32 s62, s62, 2
    s_lshr_b32 s64, s63, 3
    s_add_u32 s62, s62, s64
    s_lshl_b32 s76, s62, 1
    s_add_u32 s76, s76, s61
    s_and_b32 s76, s76, 7
    s_lshl_b32 s77, s76, 7
    s_mov_b32 s76, s77
    v_lshrrev_b32 v2, 3, v1
    v_and_b32 v3, 7, v1
    v_lshrrev_b32 v5, 1, v2
    v_xor_b32 v5, v5, v3
    v_lshlrev_b32 v5, 4, v5
    v_lshl_add_u32 v48, v2, 10, v5
    v_xor_b32 v49, 64, v48
    v_add_u32 v49, 7168, v49
    v_lshrrev_b32 v6, 2, v2
    v_bfe_u32 v7, v2, 1, 1
    v_lshl_add_u32 v6, v6, 4, v7
    v_and_b32 v7, 1, v2
    v_lshl_add_u32 v6, v7, 3, v6
    v_lshl_add_u32 v8, v6, 10, v5
    v_xor_b32 v6, 64, v8
    v_add_u32 v9, 1024, v6
    v_add_u32 v10, 2048, v8
    v_add_u32 v11, 3072, v6
    s_lshl_b32 s64, s61, 7
    s_lshl_b32 s65, s60, 5
    s_add_u32 s64, s64, s65
    s_lshl_b32 s64, s64, 10
    s_lshl_b32 s65, s60, 12
    s_lshl_b32 s70, s62, 5
    s_and_b32 s82, s60, 1
    s_lshl_b32 s68, s82, 4
    s_add_u32 s70, s70, s68
    s_lshl_b32 s67, s70, 10
    s_lshl_b32 s68, s82, 12
    s_lshr_b32 s83, s60, 1
    s_lshl_b32 s3, s83, 11
    s_add_u32 s68, s68, s3
    s_add_u32 s68, s68, 16384
    v_and_b32 v152, 31, v0
    v_lshrrev_b32 v170, 5, v1
    v_and_b32 v153, 15, v0
    v_add_lshl_u32 v154, v153, s70, 1
    s_lshl_b32 s69, s61, 7
    s_lshl_b32 s3, s62, 3
    s_add_u32 s69, s69, s3
    s_lshl_b32 s3, s60, 1
    s_add_u32 s69, s69, s3
    s_lshl_b32 s3, s69, 10
    v_lshlrev_b32 v6, 4, v152
    v_lshl_add_u32 v6, v170, 10, v6
    s_waitcnt lgkmcnt(0)
    s_mov_b32 s36, s4
    s_and_b32 s37, s5, 0xffff
    s_mov_b32 s38, 2097152
    s_mov_b32 s39, 0x00020000
    buffer_load_dwordx4 v[172:175], v6, s[36:39], s3 offen
    buffer_load_dwordx4 v[176:179], v6, s[36:39], s3 offen offset:512
    s_cmp_lt_u32 s60, 2
    s_cselect_b32 s40, s10, s12
    s_cselect_b32 s41, s11, s13
    s_cselect_b32 s44, s24, s26
    s_cselect_b32 s45, s25, s27
    s_and_b32 s41, s41, 0xffff
    s_mov_b32 s42, 524288
    s_mov_b32 s43, 0x20000
    s_add_u32 m0, s65, 0
    s_add_u32 s66, s64, s77
    buffer_load_dwordx4 v8, s[36:39], s66 offen offset:0 lds
    buffer_load_dwordx4 v9, s[36:39], s66 offen offset:1024 lds
    buffer_load_dwordx4 v10, s[36:39], s66 offen offset:2048 lds
    buffer_load_dwordx4 v11, s[36:39], s66 offen offset:3072 lds
    s_add_u32 m0, s68, 0
    s_add_u32 s66, s67, s77
    s_add_u32 s77, s77, 128
    s_and_b32 s77, s77, 1023
    buffer_load_dwordx4 v48, s[40:43], s66 offen offset:0 lds
    buffer_load_dwordx4 v49, s[40:43], s66 offen offset:1024 lds
    s_add_u32 s72, s34, 10747904
    s_addc_u32 s73, s35, 0
    s_load_dword s71, s[72:73], 0
    v_mov_b32 v190, s18
    v_mov_b32 v191, s19
    v_mov_b32 v4, s8
    v_mov_b32 v5, s9
    v_cmp_gt_u32 vcc, 32, v1
    v_mov_b32 v6, s6
    v_mov_b32 v7, s7
    v_cndmask_b32 v190, v190, v4, vcc
    v_cndmask_b32 v191, v191, v5, vcc
    v_cmp_gt_u32 vcc, 16, v1
    s_nop 1
    v_cndmask_b32 v190, v190, v6, vcc
    v_cndmask_b32 v191, v191, v7, vcc
    v_add_co_u32 v190, vcc, v190, v154
    s_nop 1
    v_addc_co_u32 v191, vcc, 0, v191, vcc
    global_load_ushort v155, v[190:191], off
    s_add_u32 m0, s65, 24576
    s_add_u32 s66, s64, s77
    buffer_load_dwordx4 v8, s[36:39], s66 offen offset:0 lds
    buffer_load_dwordx4 v9, s[36:39], s66 offen offset:1024 lds
    buffer_load_dwordx4 v10, s[36:39], s66 offen offset:2048 lds
    buffer_load_dwordx4 v11, s[36:39], s66 offen offset:3072 lds
    s_and_b32 s45, s45, 0xffff
    s_mov_b32 s47, 0x20000
    s_mov_b32 s46, 1409024
    s_lshl_b32 s63, s2, 1
    s_add_u32 s63, s63, s82
    s_mul_i32 s63, s63, 2816
    v_min_u32 v5, 21, v1
    v_lshl_add_u32 v171, v5, 7, s63
    buffer_load_dword v169, v171, s[44:47], 0 offen
    v_bfe_u32 v5, v152, 1, 3
    v_xor_b32 v5, v5, v170
    v_lshlrev_b32 v5, 4, v5
    v_lshl_add_u32 v5, v152, 7, v5
    s_lshl_b32 s3, s60, 5
    v_xor_b32 v5, s3, v5
    s_xor_b32 s63, s65, 4096
    s_lshl_b32 s3, s82, 12
    s_add_u32 s3, s3, 16384
    v_xor_b32 v6, 0, v5
    v_add_u32 v44, s65, v6
    v_add_u32 v12, s63, v6
    v_add_u32 v16, s3, v6
    v_xor_b32 v6, 32, v5
    v_add_u32 v45, s65, v6
    v_add_u32 v13, s63, v6
    v_add_u32 v17, s3, v6
    v_xor_b32 v6, 64, v5
    v_add_u32 v46, s65, v6
    v_add_u32 v14, s63, v6
    v_add_u32 v18, s3, v6
    v_xor_b32 v6, 96, v5
    v_add_u32 v47, s65, v6
    v_add_u32 v15, s63, v6
    v_add_u32 v19, s3, v6
    v_bfe_u32 v5, v1, 4, 1
    v_lshlrev_b32 v5, 2, v5
    v_and_b32 v6, 7, v1
    v_cmp_eq_u32 vcc, v5, v6
    v_mov_b32 v7, 0x3f803f80
    s_nop 0
    v_cndmask_b32 v64, 0, v7, vcc
    v_mov_b32 v65, v64
    v_mov_b32 v66, v64
    v_mov_b32 v67, v64
    s_mov_b32 s56, s34
    s_and_b32 s57, s35, 0xffff
    s_mov_b32 s58, 11534336
    s_mov_b32 s59, 0x00020000
    s_lshl_b32 s3, s69, 4
    s_add_u32 s3, s3, 10485760
    v_lshl_add_u32 v5, v170, 4, s3
    v_mov_b32 v6, 2147483632
    v_cmp_eq_u32 vcc, 0, v152
    s_nop 1
    v_cndmask_b32 v180, v6, v5, vcc
    s_mov_b32 s48, s24
    s_and_b32 s49, s25, 0xffff
    s_mov_b32 s50, 1409024
    s_mov_b32 s51, 0x00020000
    s_mov_b32 s52, s26
    s_and_b32 s53, s27, 0xffff
    s_mov_b32 s54, 1409024
    s_mov_b32 s55, 0x00020000
    s_mul_i32 s93, s62, 3
    s_lshl_b32 s74, s62, 1
    s_add_u32 s74, s74, 11
    s_min_u32 s93, s93, s74
    s_cmp_lt_u32 s62, 11
    s_cselect_b32 s89, 0, 0x40000000
    v_mul_u32_u24 v7, 5462, v1
    v_lshrrev_b32 v7, 16, v7
    v_mul_u32_u24 v5, 12, v7
    v_sub_u32 v5, v1, v5
    v_mul_u32_u24 v7, 2752, v7
    v_lshl_add_u32 v7, v5, 4, v7
    v_lshlrev_b32 v5, 27, v5
    v_and_b32 v5, s89, v5
    v_add_u32 v50, v7, v5
    v_xor_b32 v53, 32, v50
    v_add_u32 v6, 64, v1
    v_mul_u32_u24 v7, 5462, v6
    v_lshrrev_b32 v7, 16, v7
    v_mul_u32_u24 v5, 12, v7
    v_sub_u32 v5, v6, v5
    v_mul_u32_u24 v7, 2752, v7
    v_lshl_add_u32 v7, v5, 4, v7
    v_lshlrev_b32 v5, 27, v5
    v_and_b32 v5, s89, v5
    v_add_u32 v51, v7, v5
    v_subrev_u32 v51, 1024, v51
    v_xor_b32 v54, 32, v51
    v_add_u32 v6, 128, v1
    v_mul_u32_u24 v7, 5462, v6
    v_lshrrev_b32 v7, 16, v7
    v_mul_u32_u24 v5, 12, v7
    v_sub_u32 v5, v6, v5
    v_mul_u32_u24 v7, 2752, v7
    v_lshl_add_u32 v7, v5, 4, v7
    v_lshlrev_b32 v5, 27, v5
    v_and_b32 v5, s89, v5
    v_add_u32 v52, v7, v5
    v_subrev_u32 v52, 2048, v52
    v_xor_b32 v55, 32, v52
    s_lshl_b32 s3, s93, 1
    s_add_u32 s3, s3, s82
    s_add_u32 s3, s3, 64
    s_lshl_b32 s90, s3, 11
    s_add_u32 s91, s90, 4096
    s_add_u32 s89, s89, 8192
    s_lshl_b32 s74, s93, 6
    s_mul_i32 s75, s60, 44032
    s_add_u32 s74, s74, s75
    s_mul_i32 s75, s60, 6144
    v_bfe_u32 v5, v1, 4, 1
    v_bfe_u32 v6, v1, 2, 2
    v_lshl_add_u32 v6, v170, 3, v6
    v_mul_u32_u24 v7, 192, v6
    v_and_b32 v6, 3, v1
    v_lshl_add_u32 v7, v6, 3, v7
    s_lshl_b32 s3, s82, 6
    s_sub_u32 s63, 3104, s3
    v_mul_u32_u24 v6, s63, v5
    v_add_u32 v6, v6, v7
    s_lshl_b32 s63, s82, 5
    s_xor_b32 s3, s60, 0
    s_mul_i32 s3, s3, 6144
    s_add_u32 s3, s3, s63
    v_add_u32 v60, s3, v6
    v_add_u32 v56, 73728, v60
    s_xor_b32 s3, s60, 1
    s_mul_i32 s3, s3, 6144
    s_add_u32 s3, s3, s63
    v_add_u32 v61, s3, v6
    v_add_u32 v57, 73728, v61
    s_xor_b32 s3, s60, 2
    s_mul_i32 s3, s3, 6144
    s_add_u32 s3, s3, s63
    v_add_u32 v62, s3, v6
    v_add_u32 v58, 73728, v62
    s_xor_b32 s3, s60, 3
    s_mul_i32 s3, s3, 6144
    s_add_u32 s3, s3, s63
    v_add_u32 v63, s3, v6
    v_add_u32 v59, 73728, v63
    s_mov_b32 s78, 8000000
    s_mov_b32 s79, 0xffff0000
    v_bfe_u32 v5, v1, 2, 1
    v_lshlrev_b32 v5, 4, v5
    v_bfe_u32 v7, v1, 3, 2
    v_lshl_add_u32 v6, v7, 1, v5
    v_lshl_add_u32 v5, v7, 2, v5
    v_and_b32 v7, 3, v1
    v_add_u32 v7, v5, v7
    v_bfe_u32 v5, v1, 1, 1
    v_add_u32 v6, v6, v5
    v_and_b32 v5, 1, v1
    v_lshl_add_u32 v6, v5, 3, v6
    v_xor_b32 v5, s60, v170
    v_lshl_add_u32 v5, v5, 5, v6
    s_lshl_b32 s3, s61, 11
    s_add_u32 s3, s3, 10485760
    v_lshl_add_u32 v40, v5, 4, s3
    s_lshl_b32 s19, s60, 8
    s_add_u32 s19, s19, 153600
    v_lshl_add_u32 v7, v170, 5, v7
    v_lshl_add_u32 v41, v7, 2, s19
    v_bfe_u32 v5, v1, 4, 1
    v_xor_b32 v5, s60, v5
    v_lshl_add_u32 v185, v5, 1, v170
    s_lshl_b32 s3, s82, 7
    s_add_u32 s3, s3, 147456
    v_lshl_add_u32 v253, v153, 3, s3
    v_lshl_add_u32 v252, v185, 8, v253
    s_lshl_b32 s3, s83, 9
    s_lshl_b32 s63, s82, 10
    s_add_u32 s3, s3, s63
    s_add_u32 s3, s3, 147456
    v_lshl_add_u32 v254, v152, 4, s3
    v_lshlrev_b32 v5, 4, v185
    v_cvt_f32_u32 v182, v5
    s_sub_u32 s3, s61, 1
    v_lshlrev_b32 v5, 1, v185
    v_sub_u32 v5, s3, v5
    v_subrev_u32 v7, 1, v5
    v_cmp_le_i32 s[96:97], 0, v5
    v_cmp_le_i32 s[98:99], 0, v7
    v_max_i32 v5, 0, v5
    v_max_i32 v7, 0, v7
    v_lshlrev_b32 v5, 7, v5
    v_lshlrev_b32 v7, 7, v7
    v_cvt_f32_u32 v183, v5
    v_cvt_f32_u32 v184, v7
    s_and_b32 s3, s2, 7
    s_lshr_b32 s63, s2, 3
    s_lshl_b32 s80, s3, 2
    s_lshr_b32 s3, s63, 3
    s_add_u32 s80, s80, s3
    s_and_b32 s81, s63, 7
    s_cmp_lt_u32 s60, 2
    s_cselect_b32 s12, s14, s16
    s_cselect_b32 s13, s15, s17
    s_and_b32 s13, s13, 0xffff
    s_mov_b32 s14, 524288
    s_mov_b32 s15, 0x20000
    s_mov_b32 s24, s28
    s_and_b32 s25, s29, 0xffff
    s_mov_b32 s26, 1409024
    s_mov_b32 s27, 0x00020000
    s_lshl_b32 s84, s81, 16
    s_lshl_b32 s3, s82, 9
    s_add_u32 s84, s84, s3
    s_and_b32 s4, s80, 3
    s_lshl_b32 s3, s4, 7
    s_add_u32 s84, s84, s3
    s_add_u32 s18, s84, 32768
    s_lshl_b32 s16, s2, 1
    s_add_u32 s16, s16, s82
    s_lshl_b32 s16, s16, 10
    s_lshl_b32 s17, s2, 2
    s_add_u32 s17, s17, s60
    s_mul_i32 s17, s17, 1408
    s_mul_i32 s3, s80, 307200
    s_add_u32 s8, s34, s3
    s_addc_u32 s9, s35, 0
    s_and_b32 s9, s9, 0xffff
    s_mov_b32 s10, 307200
    s_mov_b32 s11, 0x20000
    s_mul_i32 s86, s60, 34816
    s_lshl_b32 s3, s4, 13
    s_add_u32 s86, s86, s3
    s_lshl_b32 s3, s82, 4
    s_lshl_b32 s72, 0xffff, s3
    s_lshl_b32 s3, s60, 1
    s_lshl_b32 s73, 0x03030303, s3
    s_xor_b32 s3, s4, 0
    s_lshl_b32 s3, s3, 2
    s_add_u32 s3, s3, s60
    s_mul_i32 s63, s3, 3
    s_lshl_b32 s3, s3, 1
    s_add_u32 s3, s3, 11
    s_min_u32 s3, s3, s63
    s_add_u32 s3, s3, 32
    s_lshl_b32 s22, s3, 12
    s_xor_b32 s3, s4, 1
    s_lshl_b32 s3, s3, 2
    s_add_u32 s3, s3, s60
    s_mul_i32 s63, s3, 3
    s_lshl_b32 s3, s3, 1
    s_add_u32 s3, s3, 11
    s_min_u32 s3, s3, s63
    s_add_u32 s3, s3, 32
    s_lshl_b32 s23, s3, 12
    s_xor_b32 s3, s4, 2
    s_lshl_b32 s3, s3, 2
    s_add_u32 s3, s3, s60
    s_mul_i32 s63, s3, 3
    s_lshl_b32 s3, s3, 1
    s_add_u32 s3, s3, 11
    s_min_u32 s3, s3, s63
    s_add_u32 s3, s3, 32
    s_lshl_b32 s32, s3, 12
    s_xor_b32 s3, s4, 3
    s_lshl_b32 s3, s3, 2
    s_add_u32 s3, s3, s60
    s_mul_i32 s63, s3, 3
    s_lshl_b32 s3, s3, 1
    s_add_u32 s3, s3, 11
    s_min_u32 s3, s3, s63
    s_add_u32 s3, s3, 32
    s_lshl_b32 s33, s3, 12
    s_add_u32 s3, s4, 0
    s_sub_u32 s63, s3, 3
    s_cselect_b32 s3, s3, s63
    s_lshl_b32 s3, s3, 2
    s_add_u32 s3, s3, s60
    s_mul_i32 s63, s3, 3
    s_add_u32 s63, s63, 34
    s_cmp_lt_u32 s3, 11
    s_cselect_b32 s3, s63, 76
    s_lshl_b32 s87, s3, 12
    s_add_u32 s3, s4, 1
    s_sub_u32 s63, s3, 3
    s_cselect_b32 s3, s3, s63
    s_lshl_b32 s3, s3, 2
    s_add_u32 s3, s3, s60
    s_mul_i32 s63, s3, 3
    s_add_u32 s63, s63, 34
    s_cmp_lt_u32 s3, 11
    s_cselect_b32 s3, s63, 76
    s_lshl_b32 s92, s3, 12
    s_add_u32 s3, s4, 2
    s_sub_u32 s63, s3, 3
    s_cselect_b32 s3, s3, s63
    s_lshl_b32 s3, s3, 2
    s_add_u32 s3, s3, s60
    s_mul_i32 s63, s3, 3
    s_add_u32 s63, s63, 34
    s_cmp_lt_u32 s3, 11
    s_cselect_b32 s3, s63, 76
    s_lshl_b32 s5, s3, 12
    s_lshl_b32 s85, s81, 7
    s_sub_u32 s85, s85, 1048576
    s_waitcnt vmcnt(13)
    v_lshlrev_b32 v128, 16, v172
    s_add_u32 m0, s68, 24576
    s_add_u32 s66, s67, s77
    s_add_u32 s77, s77, 128
    s_and_b32 s77, s77, 1023
    buffer_load_dwordx4 v48, s[40:43], s66 offen offset:0 lds
    v_and_b32 v129, s79, v172
    v_lshlrev_b32 v130, 16, v173
    v_and_b32 v131, s79, v173
    v_lshlrev_b32 v132, 16, v174
    v_and_b32 v133, s79, v174
    v_lshlrev_b32 v134, 16, v175
    v_and_b32 v135, s79, v175
    s_waitcnt vmcnt(13)
    v_lshlrev_b32 v136, 16, v176
    v_and_b32 v137, s79, v176
    v_lshlrev_b32 v138, 16, v177
    v_and_b32 v139, s79, v177
    v_lshlrev_b32 v140, 16, v178
    v_and_b32 v141, s79, v178
    v_lshlrev_b32 v142, 16, v179
    v_and_b32 v143, s79, v179
    v_pk_add_f32 v[144:145], v[128:129], v[130:131]
    v_pk_add_f32 v[144:145], v[144:145], v[132:133]
    v_pk_add_f32 v[144:145], v[144:145], v[134:135]
    v_pk_add_f32 v[144:145], v[144:145], v[136:137]
    v_pk_add_f32 v[144:145], v[144:145], v[138:139]
    v_pk_add_f32 v[144:145], v[144:145], v[140:141]
    buffer_load_dwordx4 v49, s[40:43], s66 offen offset:1024 lds
    v_pk_add_f32 v[144:145], v[144:145], v[142:143]
    v_add_f32 v144, v144, v145
    s_nop 1
    v_add_f32_dpp v144, v144, v144 quad_perm:[1,0,3,2] row_mask:0xf bank_mask:0xf
    s_nop 1
    v_add_f32_dpp v144, v144, v144 quad_perm:[2,3,0,1] row_mask:0xf bank_mask:0xf
    s_nop 1
    v_add_f32_dpp v144, v144, v144 row_half_mirror row_mask:0xf bank_mask:0xf
    s_nop 1
    v_add_f32_dpp v144, v144, v144 row_mirror row_mask:0xf bank_mask:0xf
    v_mov_b32 v145, v144
    s_nop 1
    v_permlane16_swap_b32 v144, v145
    v_add_f32 v144, v144, v145
    v_mul_f32 v144, 0x3b000000, v144
    v_pk_add_f32 v[128:129], v[128:129], v[144:145] op_sel_hi:[1,0] neg_lo:[0,1] neg_hi:[0,1]
    v_pk_add_f32 v[130:131], v[130:131], v[144:145] op_sel_hi:[1,0] neg_lo:[0,1] neg_hi:[0,1]
    v_pk_add_f32 v[132:133], v[132:133], v[144:145] op_sel_hi:[1,0] neg_lo:[0,1] neg_hi:[0,1]
    v_pk_add_f32 v[134:135], v[134:135], v[144:145] op_sel_hi:[1,0] neg_lo:[0,1] neg_hi:[0,1]
    v_pk_add_f32 v[136:137], v[136:137], v[144:145] op_sel_hi:[1,0] neg_lo:[0,1] neg_hi:[0,1]
    v_pk_add_f32 v[138:139], v[138:139], v[144:145] op_sel_hi:[1,0] neg_lo:[0,1] neg_hi:[0,1]
    v_pk_add_f32 v[140:141], v[140:141], v[144:145] op_sel_hi:[1,0] neg_lo:[0,1] neg_hi:[0,1]
    v_pk_add_f32 v[142:143], v[142:143], v[144:145] op_sel_hi:[1,0] neg_lo:[0,1] neg_hi:[0,1]
    v_pk_mul_f32 v[146:147], v[128:129], v[128:129]
    v_pk_fma_f32 v[146:147], v[130:131], v[130:131], v[146:147]
    s_add_u32 m0, s65, 49152
    s_add_u32 s66, s64, s77
    buffer_load_dwordx4 v8, s[36:39], s66 offen offset:0 lds
    v_pk_fma_f32 v[146:147], v[132:133], v[132:133], v[146:147]
    v_pk_fma_f32 v[146:147], v[134:135], v[134:135], v[146:147]
    v_pk_fma_f32 v[146:147], v[136:137], v[136:137], v[146:147]
    v_pk_fma_f32 v[146:147], v[138:139], v[138:139], v[146:147]
    v_pk_fma_f32 v[146:147], v[140:141], v[140:141], v[146:147]
    v_pk_fma_f32 v[146:147], v[142:143], v[142:143], v[146:147]
    v_add_f32 v146, v146, v147
    s_nop 1
    v_add_f32_dpp v146, v146, v146 quad_perm:[1,0,3,2] row_mask:0xf bank_mask:0xf
    s_nop 1
    v_add_f32_dpp v146, v146, v146 quad_perm:[2,3,0,1] row_mask:0xf bank_mask:0xf
    s_nop 1
    v_add_f32_dpp v146, v146, v146 row_half_mirror row_mask:0xf bank_mask:0xf
    s_nop 1
    v_add_f32_dpp v146, v146, v146 row_mirror row_mask:0xf bank_mask:0xf
    v_mov_b32 v147, v146
    s_nop 1
    v_permlane16_swap_b32 v146, v147
    v_add_f32 v146, v146, v147
    s_nop 0
    s_waitcnt lgkmcnt(0)
    s_mul_i32 s71, s71, 0x9E3779B1
    s_add_u32 s71, s71, 0x7F4A7C15
    v_mul_f32 v146, 0x3b000000, v146
    v_cvt_pk_bf16_f32 v144, v144, v146
    buffer_load_dwordx4 v9, s[36:39], s66 offen offset:1024 lds
    v_and_b32 v146, s79, v144
    v_lshlrev_b32 v148, 16, v144
    v_add_f32 v146, 0x3727c5ac, v146
    v_cvt_pk_bf16_f32 v146, v146, v146
    v_and_b32 v146, s79, v146
    v_sqrt_f32 v146, v146
    v_mov_b32 v149, s71
    v_cvt_pk_bf16_f32 v146, v146, v146
    v_and_b32 v146, s79, v146
    v_rcp_f32 v150, v146
    v_mov_b32 v151, s71
    buffer_store_dwordx4 v[148:151], v180, s[56:59], 0 offen sc1
    s_waitcnt vmcnt(10)
    v_lshlrev_b32 v155, 16, v155
    v_mov_b32 v157, v155
    buffer_load_dwordx4 v10, s[36:39], s66 offen offset:2048 lds
    s_nop 0
    v_permlane32_swap_b32 v155, v157
    v_mov_b32 v156, v155
    s_nop 1
    v_permlane16_swap_b32 v155, v156
    v_mul_f32 v157, 0x3fb8aa3b, v157
    v_exp_f32 v157, v157
    v_mul_f32 v4, v155, v155
    v_cvt_pk_bf16_f32 v157, v157, v157
    v_and_b32 v157, s79, v157
    v_mul_f32 v158, v157, v155
    v_mul_f32 v159, v157, v156
    v_mul_f32 v158, 0x3fb8aa3b, v158
    v_mul_f32 v159, 0x3e22f983, v159
    v_fmac_f32 v4, v156, v156
    v_rcp_f32 v4, v4
    v_exp_f32 v160, v158
    v_rndne_f32 v162, v159
    v_sub_f32 v161, v159, v162
    buffer_load_dwordx4 v11, s[36:39], s66 offen offset:3072 lds
    v_cos_f32 v162, v161
    v_sin_f32 v163, v161
    v_mul_f32 v80, v160, v162
    v_mul_f32 v81, v160, v163
    v_mul_f32 v160, 0x41000000, v158
    v_mul_f32 v161, 0x41000000, v159
    v_exp_f32 v160, v160
    v_rndne_f32 v162, v161
    v_sub_f32 v161, v161, v162
    v_cos_f32 v162, v161
    v_sin_f32 v163, v161
    v_mul_f32 v82, v160, v162
    v_mul_f32 v83, v160, v163
    v_mul_f32 v160, v182, v158
    v_mul_f32 v161, v182, v159
    v_exp_f32 v160, v160
    s_add_u32 m0, s68, 49152
    s_add_u32 s66, s67, s77
    s_add_u32 s77, s77, 128
    s_and_b32 s77, s77, 1023
    buffer_load_dwordx4 v48, s[40:43], s66 offen offset:0 lds
    v_rndne_f32 v162, v161
    v_sub_f32 v161, v161, v162
    v_cos_f32 v162, v161
    v_sin_f32 v163, v161
    v_mul_f32 v84, v160, v162
    v_mul_f32 v85, v160, v163
    v_mul_f32 v160, v183, v158
    v_mul_f32 v161, v183, v159
    v_exp_f32 v160, v160
    v_rndne_f32 v162, v161
    v_sub_f32 v161, v161, v162
    v_cos_f32 v162, v161
    v_sin_f32 v163, v161
    v_mul_f32 v88, v160, v162
    v_mul_f32 v89, v160, v163
    buffer_load_dwordx4 v49, s[40:43], s66 offen offset:1024 lds
    v_mul_f32 v160, v184, v158
    v_mul_f32 v161, v184, v159
    v_exp_f32 v160, v160
    v_rndne_f32 v162, v161
    v_sub_f32 v161, v161, v162
    v_cos_f32 v162, v161
    v_sin_f32 v163, v161
    v_mul_f32 v90, v160, v162
    v_mul_f32 v91, v160, v163
    v_add_f32 v5, -1.0, v80
    v_add_f32 v4, v4, v4
    v_mul_f32 v6, v5, v155
    v_fmac_f32 v6, v81, v156
    v_mul_f32 v7, v81, v155
    v_fma_f32 v7, -v5, v156, v7
    v_mul_f32 v86, v6, v4
    v_mul_f32 v87, v7, v4
    s_nop 0
    s_waitcnt lgkmcnt(0)
    s_barrier
    ds_read_b128 a[0:3], v44 offset:0
    ds_read_b128 v[24:27], v16 offset:0
    ds_read_b128 a[128:131], v12 offset:0
    ds_read_b128 a[4:7], v45 offset:0
    ds_read_b128 v[28:31], v17 offset:0
    ds_read_b128 a[132:135], v13 offset:0
    ds_read_b128 a[8:11], v46 offset:0
    ds_read_b128 v[32:35], v18 offset:0
    ds_read_b128 a[136:139], v14 offset:0
    s_waitcnt lgkmcnt(7)
    v_mfma_f32_32x32x16_bf16 v[96:111], a[0:3], v[24:27], 0
    ds_read_b128 a[12:15], v47 offset:0
    ds_read_b128 v[36:39], v19 offset:0
    v_mfma_f32_16x16x32_bf16 v[20:23], v[64:67], v[24:27], 0
    s_add_u32 m0, s65, 73728
    s_add_u32 s66, s64, s77
    buffer_load_dwordx4 v8, s[36:39], s66 offen offset:0 lds
    buffer_load_dwordx4 v9, s[36:39], s66 offen offset:1024 lds
    buffer_load_dwordx4 v10, s[36:39], s66 offen offset:2048 lds
    buffer_load_dwordx4 v11, s[36:39], s66 offen offset:3072 lds
    s_add_u32 m0, s68, 73728
    s_add_u32 s66, s67, s77
    s_add_u32 s77, s77, 128
    s_and_b32 s77, s77, 1023
    buffer_load_dwordx4 v48, s[40:43], s66 offen offset:0 lds
    buffer_load_dwordx4 v49, s[40:43], s66 offen offset:1024 lds
    s_waitcnt lgkmcnt(8)
    v_mfma_f32_32x32x16_bf16 v[112:127], a[128:131], v[24:27], 0
    ds_read_b128 a[140:143], v15 offset:0
    s_waitcnt vmcnt(13)
    s_barrier
    s_waitcnt lgkmcnt(7)
    v_mfma_f32_32x32x16_bf16 v[96:111], a[4:7], v[28:31], v[96:111]
    ds_read_b128 a[16:19], v44 offset:24576
    ds_read_b128 v[24:27], v16 offset:24576
    v_mfma_f32_16x16x32_bf16 v[20:23], v[64:67], v[28:31], v[20:23]
    s_add_u32 m0, s65, 98304
    s_add_u32 s66, s64, s77
    s_waitcnt lgkmcnt(3)
    v_mfma_f32_32x32x16_bf16 v[112:127], a[132:135], v[28:31], v[112:127]
    ds_read_b128 a[144:147], v12 offset:24576
    buffer_load_dwordx4 v8, s[36:39], s66 offen offset:0 lds
    v_mfma_f32_32x32x16_bf16 v[96:111], a[8:11], v[32:35], v[96:111]
    ds_read_b128 a[20:23], v45 offset:24576
    ds_read_b128 v[28:31], v17 offset:24576
    v_mfma_f32_32x32x16_bf16 v[112:127], a[136:139], v[32:35], v[112:127]
    ds_read_b128 a[148:151], v13 offset:24576
    buffer_load_dwordx4 v9, s[36:39], s66 offen offset:1024 lds
    buffer_load_dwordx4 v10, s[36:39], s66 offen offset:2048 lds
    v_mfma_f32_32x32x16_bf16 v[96:111], a[12:15], v[36:39], v[96:111]
    ds_read_b128 a[24:27], v46 offset:24576
    ds_read_b128 v[32:35], v18 offset:24576
    s_waitcnt lgkmcnt(5)
    v_mfma_f32_32x32x16_bf16 v[112:127], a[140:143], v[36:39], v[112:127]
    ds_read_b128 a[152:155], v14 offset:24576
    buffer_load_dwordx4 v11, s[36:39], s66 offen offset:3072 lds
    s_add_u32 m0, s68, 98304
    s_add_u32 s66, s67, s77
    s_add_u32 s77, s77, 128
    s_and_b32 s77, s77, 1023
    v_mfma_f32_32x32x16_bf16 v[96:111], a[16:19], v[24:27], v[96:111]
    ds_read_b128 a[28:31], v47 offset:24576
    ds_read_b128 v[36:39], v19 offset:24576
    v_mfma_f32_16x16x32_bf16 v[20:23], v[64:67], v[24:27], v[20:23]
    buffer_load_dwordx4 v48, s[40:43], s66 offen offset:0 lds
    v_mfma_f32_32x32x16_bf16 v[112:127], a[144:147], v[24:27], v[112:127]
    ds_read_b128 a[156:159], v15 offset:24576
    buffer_load_dwordx4 v49, s[40:43], s66 offen offset:1024 lds
    s_waitcnt vmcnt(12)
    s_barrier
    s_waitcnt lgkmcnt(4)
    v_mfma_f32_32x32x16_bf16 v[96:111], a[20:23], v[28:31], v[96:111]
    ds_read_b128 a[32:35], v44 offset:49152
    ds_read_b128 v[24:27], v16 offset:49152
    v_mfma_f32_16x16x32_bf16 v[20:23], v[64:67], v[28:31], v[20:23]
    s_add_u32 m0, s65, 0
    s_add_u32 s66, s64, s77
    v_mfma_f32_32x32x16_bf16 v[112:127], a[148:151], v[28:31], v[112:127]
    ds_read_b128 a[160:163], v12 offset:49152
    buffer_load_dwordx4 v8, s[36:39], s66 offen offset:0 lds
    v_mfma_f32_32x32x16_bf16 v[96:111], a[24:27], v[32:35], v[96:111]
    ds_read_b128 a[36:39], v45 offset:49152
    ds_read_b128 v[28:31], v17 offset:49152
    s_waitcnt lgkmcnt(5)
    v_mfma_f32_32x32x16_bf16 v[112:127], a[152:155], v[32:35], v[112:127]
    ds_read_b128 a[164:167], v13 offset:49152
    buffer_load_dwordx4 v9, s[36:39], s66 offen offset:1024 lds
    buffer_load_dwordx4 v10, s[36:39], s66 offen offset:2048 lds
    v_mfma_f32_32x32x16_bf16 v[96:111], a[28:31], v[36:39], v[96:111]
    ds_read_b128 a[40:43], v46 offset:49152
    ds_read_b128 v[32:35], v18 offset:49152
    v_mfma_f32_32x32x16_bf16 v[112:127], a[156:159], v[36:39], v[112:127]
    ds_read_b128 a[168:171], v14 offset:49152
    buffer_load_dwordx4 v11, s[36:39], s66 offen offset:3072 lds
    s_add_u32 m0, s68, 0
    s_add_u32 s66, s67, s77
    s_add_u32 s77, s77, 128
    s_and_b32 s77, s77, 1023
    s_waitcnt lgkmcnt(4)
    v_mfma_f32_32x32x16_bf16 v[96:111], a[32:35], v[24:27], v[96:111]
    ds_read_b128 a[44:47], v47 offset:49152
    ds_read_b128 v[36:39], v19 offset:49152
    v_mfma_f32_16x16x32_bf16 v[20:23], v[64:67], v[24:27], v[20:23]
    buffer_load_dwordx4 v48, s[40:43], s66 offen offset:0 lds
    v_mfma_f32_32x32x16_bf16 v[112:127], a[160:163], v[24:27], v[112:127]
    ds_read_b128 a[172:175], v15 offset:49152
    buffer_load_dwordx4 v49, s[40:43], s66 offen offset:1024 lds
    s_waitcnt vmcnt(12)
    s_barrier
    s_mov_b32 s88, 0x12000
    v_add_u32 v12, s88, v12
    v_add_u32 v13, s88, v13
    v_add_u32 v14, s88, v14
    v_add_u32 v15, s88, v15
    v_add_u32 v16, s88, v16
    v_add_u32 v17, s88, v17
    v_add_u32 v18, s88, v18
    v_add_u32 v19, s88, v19
    v_add_u32 v44, s88, v44
    v_add_u32 v45, s88, v45
    v_add_u32 v46, s88, v46
    v_add_u32 v47, s88, v47
    v_mfma_f32_32x32x16_bf16 v[96:111], a[36:39], v[28:31], v[96:111]
    ds_read_b128 a[48:51], v44 offset:0
    ds_read_b128 v[24:27], v16 offset:0
    v_mfma_f32_16x16x32_bf16 v[20:23], v[64:67], v[28:31], v[20:23]
    s_add_u32 m0, s65, 24576
    s_add_u32 s66, s64, s77
    s_waitcnt lgkmcnt(3)
    v_mfma_f32_32x32x16_bf16 v[112:127], a[164:167], v[28:31], v[112:127]
    ds_read_b128 a[176:179], v12 offset:0
    buffer_load_dwordx4 v8, s[36:39], s66 offen offset:0 lds
    v_mfma_f32_32x32x16_bf16 v[96:111], a[40:43], v[32:35], v[96:111]
    ds_read_b128 a[52:55], v45 offset:0
    ds_read_b128 v[28:31], v17 offset:0
    v_mfma_f32_32x32x16_bf16 v[112:127], a[168:171], v[32:35], v[112:127]
    ds_read_b128 a[180:183], v13 offset:0
    buffer_load_dwordx4 v9, s[36:39], s66 offen offset:1024 lds
    buffer_load_dwordx4 v10, s[36:39], s66 offen offset:2048 lds
    v_mfma_f32_32x32x16_bf16 v[96:111], a[44:47], v[36:39], v[96:111]
    ds_read_b128 a[56:59], v46 offset:0
    ds_read_b128 v[32:35], v18 offset:0
    s_waitcnt lgkmcnt(5)
    v_mfma_f32_32x32x16_bf16 v[112:127], a[172:175], v[36:39], v[112:127]
    ds_read_b128 a[184:187], v14 offset:0
    buffer_load_dwordx4 v11, s[36:39], s66 offen offset:3072 lds
    s_add_u32 m0, s68, 24576
    s_add_u32 s66, s67, s77
    s_add_u32 s77, s77, 128
    s_and_b32 s77, s77, 1023
    v_mfma_f32_32x32x16_bf16 v[96:111], a[48:51], v[24:27], v[96:111]
    ds_read_b128 a[60:63], v47 offset:0
    ds_read_b128 v[36:39], v19 offset:0
    v_mfma_f32_16x16x32_bf16 v[20:23], v[64:67], v[24:27], v[20:23]
    buffer_load_dwordx4 v48, s[40:43], s66 offen offset:0 lds
    v_mfma_f32_32x32x16_bf16 v[112:127], a[176:179], v[24:27], v[112:127]
    ds_read_b128 a[188:191], v15 offset:0
    buffer_load_dwordx4 v49, s[40:43], s66 offen offset:1024 lds
    s_waitcnt vmcnt(12)
    s_barrier
    s_waitcnt lgkmcnt(4)
    v_mfma_f32_32x32x16_bf16 v[96:111], a[52:55], v[28:31], v[96:111]
    ds_read_b128 a[64:67], v44 offset:24576
    ds_read_b128 v[24:27], v16 offset:24576
    v_mfma_f32_16x16x32_bf16 v[20:23], v[64:67], v[28:31], v[20:23]
    s_add_u32 m0, s65, 49152
    s_add_u32 s66, s64, s77
    v_mfma_f32_32x32x16_bf16 v[112:127], a[180:183], v[28:31], v[112:127]
    ds_read_b128 a[192:195], v12 offset:24576
    buffer_load_dwordx4 v8, s[36:39], s66 offen offset:0 lds
    v_mfma_f32_32x32x16_bf16 v[96:111], a[56:59], v[32:35], v[96:111]
    ds_read_b128 a[68:71], v45 offset:24576
    ds_read_b128 v[28:31], v17 offset:24576
    s_waitcnt lgkmcnt(5)
    v_mfma_f32_32x32x16_bf16 v[112:127], a[184:187], v[32:35], v[112:127]
    ds_read_b128 a[196:199], v13 offset:24576
    buffer_load_dwordx4 v9, s[36:39], s66 offen offset:1024 lds
    buffer_load_dwordx4 v10, s[36:39], s66 offen offset:2048 lds
    v_mfma_f32_32x32x16_bf16 v[96:111], a[60:63], v[36:39], v[96:111]
    ds_read_b128 a[72:75], v46 offset:24576
    ds_read_b128 v[32:35], v18 offset:24576
    v_mfma_f32_32x32x16_bf16 v[112:127], a[188:191], v[36:39], v[112:127]
    ds_read_b128 a[200:203], v14 offset:24576
    buffer_load_dwordx4 v11, s[36:39], s66 offen offset:3072 lds
    s_add_u32 m0, s68, 49152
    s_add_u32 s66, s67, s77
    s_add_u32 s77, s77, 128
    s_and_b32 s77, s77, 1023
    s_waitcnt lgkmcnt(4)
    v_mfma_f32_32x32x16_bf16 v[96:111], a[64:67], v[24:27], v[96:111]
    ds_read_b128 a[76:79], v47 offset:24576
    ds_read_b128 v[36:39], v19 offset:24576
    v_mfma_f32_16x16x32_bf16 v[20:23], v[64:67], v[24:27], v[20:23]
    buffer_load_dwordx4 v48, s[40:43], s66 offen offset:0 lds
    v_mfma_f32_32x32x16_bf16 v[112:127], a[192:195], v[24:27], v[112:127]
    ds_read_b128 a[204:207], v15 offset:24576
    buffer_load_dwordx4 v49, s[40:43], s66 offen offset:1024 lds
    s_waitcnt vmcnt(12)
    s_barrier
    s_mov_b32 s88, 0xfffee000
    v_add_u32 v12, s88, v12
    v_add_u32 v13, s88, v13
    v_add_u32 v14, s88, v14
    v_add_u32 v15, s88, v15
    v_add_u32 v16, s88, v16
    v_add_u32 v17, s88, v17
    v_add_u32 v18, s88, v18
    v_add_u32 v19, s88, v19
    v_add_u32 v44, s88, v44
    v_add_u32 v45, s88, v45
    v_add_u32 v46, s88, v46
    v_add_u32 v47, s88, v47
    v_mfma_f32_32x32x16_bf16 v[96:111], a[68:71], v[28:31], v[96:111]
    ds_read_b128 a[80:83], v44 offset:0
    ds_read_b128 v[24:27], v16 offset:0
    v_mfma_f32_16x16x32_bf16 v[20:23], v[64:67], v[28:31], v[20:23]
    s_mul_i32 s66, s76, 1376
    s_add_u32 s76, s76, 128
    s_and_b32 s76, s76, 1023
    s_add_u32 m0, s75, 122880
    s_add_u32 s66, s66, s74
    s_waitcnt lgkmcnt(3)
    v_mfma_f32_32x32x16_bf16 v[112:127], a[196:199], v[28:31], v[112:127]
    ds_read_b128 a[208:211], v12 offset:0
    buffer_load_dwordx4 v50, s[48:51], s66 offen offset:0 lds
    v_mfma_f32_32x32x16_bf16 v[96:111], a[72:75], v[32:35], v[96:111]
    ds_read_b128 a[84:87], v45 offset:0
    ds_read_b128 v[28:31], v17 offset:0
    v_mfma_f32_32x32x16_bf16 v[112:127], a[200:203], v[32:35], v[112:127]
    ds_read_b128 a[212:215], v13 offset:0
    buffer_load_dwordx4 v51, s[48:51], s66 offen offset:1024 lds
    buffer_load_dwordx4 v52, s[48:51], s66 offen offset:2048 lds
    v_mfma_f32_32x32x16_bf16 v[96:111], a[76:79], v[36:39], v[96:111]
    ds_read_b128 a[88:91], v46 offset:0
    ds_read_b128 v[32:35], v18 offset:0
    s_waitcnt lgkmcnt(5)
    v_mfma_f32_32x32x16_bf16 v[112:127], a[204:207], v[36:39], v[112:127]
    ds_read_b128 a[216:219], v14 offset:0
    s_add_u32 m0, s75, 125952
    s_nop 0
    buffer_load_dwordx4 v53, s[52:55], s66 offen offset:0 lds
    v_mfma_f32_32x32x16_bf16 v[96:111], a[80:83], v[24:27], v[96:111]
    ds_read_b128 a[92:95], v47 offset:0
    ds_read_b128 v[36:39], v19 offset:0
    buffer_load_dwordx4 v[248:251], v40, s[56:59], 0 offen sc1
    v_mfma_f32_16x16x32_bf16 v[20:23], v[64:67], v[24:27], v[20:23]
    buffer_load_dwordx4 v54, s[52:55], s66 offen offset:1024 lds
    v_mfma_f32_32x32x16_bf16 v[112:127], a[208:211], v[24:27], v[112:127]
    ds_read_b128 a[220:223], v15 offset:0
    buffer_load_dwordx4 v55, s[52:55], s66 offen offset:2048 lds
    s_waitcnt vmcnt(13)
    s_barrier
    s_waitcnt lgkmcnt(4)
    v_mfma_f32_32x32x16_bf16 v[96:111], a[84:87], v[28:31], v[96:111]
    ds_read_b128 a[96:99], v44 offset:24576
    ds_read_b128 v[24:27], v16 offset:24576
    v_mfma_f32_16x16x32_bf16 v[20:23], v[64:67], v[28:31], v[20:23]
    s_mul_i32 s66, s76, 1376
    s_add_u32 s76, s76, 128
    s_and_b32 s76, s76, 1023
    s_add_u32 m0, s75, 73728
    s_add_u32 s66, s66, s74
    v_mfma_f32_32x32x16_bf16 v[112:127], a[212:215], v[28:31], v[112:127]
    ds_read_b128 a[224:227], v12 offset:24576
    buffer_load_dwordx4 v50, s[48:51], s66 offen offset:0 lds
    v_mfma_f32_32x32x16_bf16 v[96:111], a[88:91], v[32:35], v[96:111]
    ds_read_b128 a[100:103], v45 offset:24576
    ds_read_b128 v[28:31], v17 offset:24576
    s_waitcnt lgkmcnt(5)
    v_mfma_f32_32x32x16_bf16 v[112:127], a[216:219], v[32:35], v[112:127]
    ds_read_b128 a[228:231], v13 offset:24576
    buffer_load_dwordx4 v51, s[48:51], s66 offen offset:1024 lds
    buffer_load_dwordx4 v52, s[48:51], s66 offen offset:2048 lds
    v_mfma_f32_32x32x16_bf16 v[96:111], a[92:95], v[36:39], v[96:111]
    ds_read_b128 a[104:107], v46 offset:24576
    ds_read_b128 v[32:35], v18 offset:24576
    v_mfma_f32_32x32x16_bf16 v[112:127], a[220:223], v[36:39], v[112:127]
    ds_read_b128 a[232:235], v14 offset:24576
    s_add_u32 m0, s75, 76800
    s_nop 0
    buffer_load_dwordx4 v53, s[52:55], s66 offen offset:0 lds
    s_waitcnt lgkmcnt(4)
    v_mfma_f32_32x32x16_bf16 v[96:111], a[96:99], v[24:27], v[96:111]
    ds_read_b128 a[108:111], v47 offset:24576
    ds_read_b128 v[36:39], v19 offset:24576
    v_mfma_f32_16x16x32_bf16 v[20:23], v[64:67], v[24:27], v[20:23]
    buffer_load_dwordx4 v54, s[52:55], s66 offen offset:1024 lds
    v_mfma_f32_32x32x16_bf16 v[112:127], a[224:227], v[24:27], v[112:127]
    ds_read_b128 a[236:239], v15 offset:24576
    buffer_load_dwordx4 v55, s[52:55], s66 offen offset:2048 lds
    s_waitcnt vmcnt(13)
    s_barrier
    v_mfma_f32_32x32x16_bf16 v[96:111], a[100:103], v[28:31], v[96:111]
    ds_read_b128 a[112:115], v44 offset:49152
    ds_read_b128 v[24:27], v16 offset:49152
    v_mfma_f32_16x16x32_bf16 v[20:23], v[64:67], v[28:31], v[20:23]
    s_waitcnt lgkmcnt(3)
    v_mfma_f32_32x32x16_bf16 v[112:127], a[228:231], v[28:31], v[112:127]
    ds_read_b128 a[240:243], v12 offset:49152
    s_mul_i32 s66, s76, 1376
    s_add_u32 s76, s76, 128
    s_and_b32 s76, s76, 1023
    s_add_u32 m0, s75, 98304
    s_add_u32 s66, s66, s74
    v_mfma_f32_32x32x16_bf16 v[96:111], a[104:107], v[32:35], v[96:111]
    ds_read_b128 a[116:119], v45 offset:49152
    ds_read_b128 v[28:31], v17 offset:49152
    v_mfma_f32_32x32x16_bf16 v[112:127], a[232:235], v[32:35], v[112:127]
    ds_read_b128 a[244:247], v13 offset:49152
    v_mfma_f32_32x32x16_bf16 v[96:111], a[108:111], v[36:39], v[96:111]
    ds_read_b128 a[120:123], v46 offset:49152
    ds_read_b128 v[32:35], v18 offset:49152
    s_waitcnt lgkmcnt(5)
    v_mfma_f32_32x32x16_bf16 v[112:127], a[236:239], v[36:39], v[112:127]
    ds_read_b128 a[248:251], v14 offset:49152
    buffer_load_dwordx4 v50, s[48:51], s66 offen offset:0 lds
    v_mfma_f32_32x32x16_bf16 v[96:111], a[112:115], v[24:27], v[96:111]
    ds_read_b128 a[124:127], v47 offset:49152
    ds_read_b128 v[36:39], v19 offset:49152
    v_mfma_f32_16x16x32_bf16 v[20:23], v[64:67], v[24:27], v[20:23]
    v_mfma_f32_32x32x16_bf16 v[112:127], a[240:243], v[24:27], v[112:127]
    ds_read_b128 a[252:255], v15 offset:49152
    buffer_load_dwordx4 v51, s[48:51], s66 offen offset:1024 lds
    s_waitcnt lgkmcnt(4)
    v_mfma_f32_32x32x16_bf16 v[96:111], a[116:119], v[28:31], v[96:111]
    buffer_load_dwordx4 v52, s[48:51], s66 offen offset:2048 lds
parallel_sum__ssm_conv_s5__glu_gated_bilinear__prompt_kernel_chkT:
    s_waitcnt vmcnt(11)
    v_cmp_ne_u32 vcc, s71, v249
    v_cmp_ne_u32 s[100:101], s71, v251
    s_nop 1
    s_or_b64 vcc, vcc, s[100:101]
    s_cbranch_scc1 parallel_sum__ssm_conv_s5__glu_gated_bilinear__prompt_kernel_slowT
parallel_sum__ssm_conv_s5__glu_gated_bilinear__prompt_kernel_goT:
    s_add_u32 m0, s75, 101376
    s_nop 0
    v_mfma_f32_16x16x32_bf16 v[20:23], v[64:67], v[28:31], v[20:23]
    ds_write_b32 v41, v250
    v_mfma_f32_32x32x16_bf16 v[112:127], a[244:247], v[28:31], v[112:127]
    buffer_load_dwordx4 v53, s[52:55], s66 offen offset:0 lds
    buffer_load_dwordx4 v54, s[52:55], s66 offen offset:1024 lds
    v_cvt_pk_bf16_f32 v93, -v248, -v248
    v_mul_f32 v92, v250, v250
    v_mov_b32 v95, v93
    v_mov_b32 v94, v92
    s_nop 0
    v_permlane32_swap_b32 v93, v95
    v_permlane32_swap_b32 v92, v94
    v_mov_b32 v248, v93
    v_mov_b32 v249, v93
    v_mov_b32 v250, v93
    v_mov_b32 v251, v93
    v_mfma_f32_32x32x16_bf16 v[96:111], a[120:123], v[32:35], v[96:111]
    buffer_load_dwordx4 v55, s[52:55], s66 offen offset:2048 lds
    s_waitcnt vmcnt(12)
    s_barrier
    ds_read_b64_tr_b16 v[224:225], v56 offset:49152
    ds_read_b64_tr_b16 v[226:227], v56 offset:49920
    ds_read_b64_tr_b16 v[228:229], v56 offset:49216
    ds_read_b64_tr_b16 v[230:231], v56 offset:49984
    s_waitcnt lgkmcnt(5)
    v_mfma_f32_32x32x16_bf16 v[112:127], a[248:251], v[32:35], v[112:127]
    ds_read_b64_tr_b16 v[232:233], v56 offset:49280
    ds_read_b64_tr_b16 v[234:235], v56 offset:50048
    v_mfma_f32_32x32x16_bf16 v[96:111], a[124:127], v[36:39], v[96:111]
    v_cvt_pk_bf16_f32 v2, v20, v20
    v_and_b32 v2, s79, v2
    v_sub_f32 v20, v20, v2
    v_cvt_pk_bf16_f32 v20, v2, v20
    ds_write_b128 v254, v[20:23] offset:4096
    v_mfma_f32_32x32x16_bf16 v[112:127], a[252:255], v[36:39], v[112:127]
    s_mul_i32 s66, s76, 1376
    s_add_u32 s76, s76, 128
    s_and_b32 s76, s76, 1023
    s_add_u32 m0, s75, 0
    s_add_u32 s66, s66, s74
    s_waitcnt lgkmcnt(3)
    v_mfma_f32_16x16x32_bf16 v[68:71], v[64:67], v[224:227], 0
    v_mfma_f32_32x32x16_bf16 v[128:143], v[224:227], a[0:3], 0
    ds_read_b64_tr_b16 v[236:237], v57 offset:49152
    ds_read_b64_tr_b16 v[238:239], v57 offset:49920
    s_waitcnt lgkmcnt(2)
    s_barrier
    v_mfma_f32_32x32x16_bf16 v[144:159], v[224:227], a[128:131], 0
    s_lshl_b32 s3, s82, 10
    s_add_u32 s3, s3, 147456
    v_lshl_add_u32 v5, v1, 4, s3
    ds_read_b128 v[24:27], v5 offset:4096
    v_bfe_u32 v5, v1, 4, 1
    v_lshrrev_b32 v6, 5, v1
    v_lshl_add_u32 v5, v5, 1, v6
    v_lshl_add_u32 v5, v5, 6, s19
    v_mov_b32 v32, v95
    v_mov_b32 v33, v95
    v_mov_b32 v34, v95
    v_mov_b32 v35, v95
    ds_read_b128 v[8:11], v5 offset:0
    buffer_load_dwordx4 v50, s[48:51], s66 offen offset:0 lds
    v_mfma_f32_16x16x32_bf16 v[72:75], v[64:67], v[228:231], 0
    ds_read_b128 v[12:15], v5 offset:16
    ds_read_b128 v[16:19], v5 offset:32
    ds_read_b128 v[20:23], v5 offset:48
    v_mfma_f32_32x32x16_bf16 v[160:175], v[228:231], a[0:3], 0
    ds_read_b64_tr_b16 v[240:241], v57 offset:49216
    ds_read_b64_tr_b16 v[242:243], v57 offset:49984
    v_mfma_f32_32x32x16_bf16 v[176:191], v[228:231], a[128:131], 0
    s_waitcnt lgkmcnt(6)
    v_mfma_f32_32x32x16_bf16 v[96:111], v[248:251], v[24:27], v[96:111]
    v_mfma_f32_32x32x16_bf16 v[112:127], v[32:35], v[24:27], v[112:127]
    s_lshl_b32 s3, s61, 13
    s_lshl_b32 s63, s70, 4
    s_add_u32 s3, s3, s63
    s_add_u32 s3, s3, 10551296
    v_mfma_f32_16x16x32_bf16 v[76:79], v[64:67], v[232:235], 0
    v_lshl_add_u32 v5, v1, 4, s3
    v_mov_b32 v6, 2147483632
    v_and_b32 v7, 0xb0, v0
    v_cmp_eq_u32 vcc, 0, v7
    v_mov_b32 v42, 0
    buffer_load_dwordx4 v51, s[48:51], s66 offen offset:1024 lds
    v_cndmask_b32 v37, v6, v5, vcc
    v_mfma_f32_32x32x16_bf16 v[192:207], v[232:235], a[0:3], 0
    ds_read_b64_tr_b16 v[244:245], v57 offset:49280
    ds_read_b64_tr_b16 v[246:247], v57 offset:50048
    v_mov_b32 v43, 0
    v_subrev_u32 v2, v253, v252
    v_mfma_f32_32x32x16_bf16 v[208:223], v[232:235], a[128:131], 0
    v_min_u32 v4, 7, v1
    v_lshlrev_b32 v4, 7, v4
    buffer_load_dword v38, v4, s[12:15], s16 offen
    v_min_u32 v4, 10, v1
    v_lshlrev_b32 v4, 7, v4
    buffer_load_dword v39, v4, s[24:27], s17 offen
    buffer_load_dwordx4 v52, s[48:51], s66 offen offset:2048 lds
    v_mfma_f32_16x16x32_bf16 v[68:71], v[64:67], v[236:239], v[68:71]
    v_mfma_f32_32x32x16_bf16 v[128:143], v[236:239], a[4:7], v[128:143]
    ds_read_b64_tr_b16 v[224:225], v58 offset:49152
    ds_read_b64_tr_b16 v[226:227], v58 offset:49920
    v_mfma_f32_32x32x16_bf16 v[144:159], v[236:239], a[132:135], v[144:159]
    s_add_u32 m0, s75, 3072
    s_nop 0
    s_waitcnt lgkmcnt(2)
    v_mfma_f32_16x16x32_bf16 v[72:75], v[64:67], v[240:243], v[72:75]
    buffer_load_dwordx4 v53, s[52:55], s66 offen offset:0 lds
    v_mfma_f32_32x32x16_bf16 v[160:175], v[240:243], a[4:7], v[160:175]
    ds_read_b64_tr_b16 v[228:229], v58 offset:49216
    ds_read_b64_tr_b16 v[230:231], v58 offset:49984
    v_mfma_f32_32x32x16_bf16 v[176:191], v[240:243], a[132:135], v[176:191]
    v_permlane16_swap_b32 v96, v112
    v_permlane16_swap_b32 v97, v113
    v_permlane16_swap_b32 v98, v114
    v_permlane16_swap_b32 v99, v115
    v_permlane16_swap_b32 v100, v116
    v_permlane16_swap_b32 v101, v117
    v_permlane16_swap_b32 v102, v118
    v_permlane16_swap_b32 v103, v119
    v_permlane16_swap_b32 v104, v120
    v_permlane16_swap_b32 v105, v121
    v_permlane16_swap_b32 v106, v122
    v_permlane16_swap_b32 v107, v123
    v_permlane16_swap_b32 v108, v124
    v_permlane16_swap_b32 v109, v125
    v_permlane16_swap_b32 v110, v126
    v_permlane16_swap_b32 v111, v127
    v_pk_mul_f32 v[96:97], v[96:97], v[8:9]
    v_pk_mul_f32 v[112:113], v[112:113], v[8:9]
    v_pk_mul_f32 v[98:99], v[98:99], v[10:11]
    v_pk_mul_f32 v[114:115], v[114:115], v[10:11]
    v_pk_mul_f32 v[100:101], v[100:101], v[12:13]
    v_pk_mul_f32 v[116:117], v[116:117], v[12:13]
    v_pk_mul_f32 v[102:103], v[102:103], v[14:15]
    v_pk_mul_f32 v[118:119], v[118:119], v[14:15]
    v_pk_mul_f32 v[104:105], v[104:105], v[16:17]
    v_pk_mul_f32 v[120:121], v[120:121], v[16:17]
    v_pk_mul_f32 v[106:107], v[106:107], v[18:19]
    v_pk_mul_f32 v[122:123], v[122:123], v[18:19]
    v_pk_mul_f32 v[108:109], v[108:109], v[20:21]
    v_pk_mul_f32 v[124:125], v[124:125], v[20:21]
    v_pk_mul_f32 v[110:111], v[110:111], v[22:23]
    v_pk_mul_f32 v[126:127], v[126:127], v[22:23]
    v_pk_fma_f32 v[12:13], v[96:97], v[80:81], v[98:99] op_sel_hi:[1,0,1]
    v_pk_fma_f32 v[14:15], v[112:113], v[80:81], v[114:115] op_sel_hi:[1,0,1]
    v_pk_fma_f32 v[12:13], v[112:113], v[80:81], v[12:13] op_sel:[0,1,0] op_sel_hi:[1,1,1] neg_lo:[1,0,0] neg_hi:[1,0,0]
    v_pk_fma_f32 v[14:15], v[96:97], v[80:81], v[14:15] op_sel:[0,1,0] op_sel_hi:[1,1,1]
    v_pk_fma_f32 v[8:9], v[12:13], v[80:81], v[100:101] op_sel_hi:[1,0,1]
    v_pk_fma_f32 v[10:11], v[14:15], v[80:81], v[116:117] op_sel_hi:[1,0,1]
    v_pk_fma_f32 v[8:9], v[14:15], v[80:81], v[8:9] op_sel:[0,1,0] op_sel_hi:[1,1,1] neg_lo:[1,0,0] neg_hi:[1,0,0]
    v_pk_fma_f32 v[10:11], v[12:13], v[80:81], v[10:11] op_sel:[0,1,0] op_sel_hi:[1,1,1]
    v_pk_fma_f32 v[12:13], v[8:9], v[80:81], v[102:103] op_sel_hi:[1,0,1]
    v_pk_fma_f32 v[14:15], v[10:11], v[80:81], v[118:119] op_sel_hi:[1,0,1]
    v_pk_fma_f32 v[12:13], v[10:11], v[80:81], v[12:13] op_sel:[0,1,0] op_sel_hi:[1,1,1] neg_lo:[1,0,0] neg_hi:[1,0,0]
    v_pk_fma_f32 v[14:15], v[8:9], v[80:81], v[14:15] op_sel:[0,1,0] op_sel_hi:[1,1,1]
    v_pk_fma_f32 v[8:9], v[12:13], v[80:81], v[104:105] op_sel_hi:[1,0,1]
    v_pk_fma_f32 v[10:11], v[14:15], v[80:81], v[120:121] op_sel_hi:[1,0,1]
    v_pk_fma_f32 v[8:9], v[14:15], v[80:81], v[8:9] op_sel:[0,1,0] op_sel_hi:[1,1,1] neg_lo:[1,0,0] neg_hi:[1,0,0]
    v_pk_fma_f32 v[10:11], v[12:13], v[80:81], v[10:11] op_sel:[0,1,0] op_sel_hi:[1,1,1]
    v_pk_fma_f32 v[12:13], v[8:9], v[80:81], v[106:107] op_sel_hi:[1,0,1]
    v_pk_fma_f32 v[14:15], v[10:11], v[80:81], v[122:123] op_sel_hi:[1,0,1]
    v_pk_fma_f32 v[12:13], v[10:11], v[80:81], v[12:13] op_sel:[0,1,0] op_sel_hi:[1,1,1] neg_lo:[1,0,0] neg_hi:[1,0,0]
    v_pk_fma_f32 v[14:15], v[8:9], v[80:81], v[14:15] op_sel:[0,1,0] op_sel_hi:[1,1,1]
    v_pk_fma_f32 v[8:9], v[12:13], v[80:81], v[108:109] op_sel_hi:[1,0,1]
    v_pk_fma_f32 v[10:11], v[14:15], v[80:81], v[124:125] op_sel_hi:[1,0,1]
    v_pk_fma_f32 v[8:9], v[14:15], v[80:81], v[8:9] op_sel:[0,1,0] op_sel_hi:[1,1,1] neg_lo:[1,0,0] neg_hi:[1,0,0]
    v_pk_fma_f32 v[10:11], v[12:13], v[80:81], v[10:11] op_sel:[0,1,0] op_sel_hi:[1,1,1]
    v_pk_fma_f32 v[12:13], v[8:9], v[80:81], v[110:111] op_sel_hi:[1,0,1]
    v_pk_fma_f32 v[14:15], v[10:11], v[80:81], v[126:127] op_sel_hi:[1,0,1]
    v_pk_fma_f32 v[12:13], v[10:11], v[80:81], v[12:13] op_sel:[0,1,0] op_sel_hi:[1,1,1] neg_lo:[1,0,0] neg_hi:[1,0,0]
    v_pk_fma_f32 v[14:15], v[8:9], v[80:81], v[14:15] op_sel:[0,1,0] op_sel_hi:[1,1,1]
    v_fma_f32 v28, v82, v12, v13
    v_fma_f32 v29, v82, v14, v15
    v_fma_f32 v28, -v83, v14, v28
    v_fmac_f32 v29, v83, v12
    ds_write_b64 v252, v[28:29]
    v_mov_b32 v24, v12
    v_mfma_f32_16x16x32_bf16 v[76:79], v[64:67], v[244:247], v[76:79]
    v_mov_b32 v25, v14
    v_mul_f32 v5, v83, v83
    v_mul_f32 v6, v82, v83
    v_fma_f32 v26, v82, v82, -v5
    v_add_f32 v27, v6, v6
    v_sub_f32 v3, 0, v27
    s_waitcnt lgkmcnt(0)
    s_barrier
    v_mfma_f32_32x32x16_bf16 v[192:207], v[244:247], a[4:7], v[192:207]
    ds_read_b64_tr_b16 v[232:233], v58 offset:49280
    ds_read_b64_tr_b16 v[234:235], v58 offset:50048
    ds_read_b64 v[8:9], v253 offset:0
    v_mfma_f32_32x32x16_bf16 v[208:223], v[244:247], a[132:135], v[208:223]
    ds_read_b64 v[10:11], v253 offset:256
    ds_read_b64 v[12:13], v253 offset:512
    ds_read_b64 v[14:15], v253 offset:768
    ds_read_b64 v[16:17], v253 offset:1024
    ds_read_b64 v[18:19], v253 offset:1280
    ds_read_b64 v[20:21], v253 offset:1536
    ds_read_b64 v[22:23], v253 offset:1792
    v_mov_b32 v29, s71
    v_mov_b32 v31, s71
    v_mfma_f32_32x32x16_bf16 v[128:143], v[224:227], a[8:11], v[128:143]
    ds_read_b64_tr_b16 v[236:237], v59 offset:49152
    ds_read_b64_tr_b16 v[238:239], v59 offset:49920
    v_mfma_f32_32x32x16_bf16 v[144:159], v[224:227], a[136:139], v[144:159]
    v_cmp_eq_u32 vcc, 256, v2
    s_waitcnt lgkmcnt(8)
    v_fmac_f32 v10, v26, v8
    v_fmac_f32 v11, v26, v9
    v_cndmask_b32 v42, v42, v8, vcc
    v_cndmask_b32 v43, v43, v9, vcc
    v_fmac_f32 v10, v3, v9
    v_fmac_f32 v11, v27, v8
    v_cmp_eq_u32 vcc, 512, v2
    s_waitcnt lgkmcnt(7)
    v_fmac_f32 v12, v26, v10
    v_fmac_f32 v13, v26, v11
    v_mfma_f32_32x32x16_bf16 v[160:175], v[228:231], a[8:11], v[160:175]
    ds_read_b64_tr_b16 v[240:241], v59 offset:49216
    ds_read_b64_tr_b16 v[242:243], v59 offset:49984
    v_cndmask_b32 v42, v42, v10, vcc
    v_cndmask_b32 v43, v43, v11, vcc
    v_mfma_f32_32x32x16_bf16 v[176:191], v[228:231], a[136:139], v[176:191]
    v_fmac_f32 v12, v3, v11
    v_fmac_f32 v13, v27, v10
    v_cmp_eq_u32 vcc, 768, v2
    s_waitcnt lgkmcnt(8)
    v_fmac_f32 v14, v26, v12
    v_fmac_f32 v15, v26, v13
    v_cndmask_b32 v42, v42, v12, vcc
    v_cndmask_b32 v43, v43, v13, vcc
    v_fmac_f32 v14, v3, v13
    v_fmac_f32 v15, v27, v12
    v_cmp_eq_u32 vcc, 1024, v2
    s_waitcnt lgkmcnt(7)
    v_fmac_f32 v16, v26, v14
    v_fmac_f32 v17, v26, v15
    v_cndmask_b32 v42, v42, v14, vcc
    v_cndmask_b32 v43, v43, v15, vcc
    v_fmac_f32 v16, v3, v15
    v_fmac_f32 v17, v27, v14
    v_cmp_eq_u32 vcc, 1280, v2
    s_waitcnt lgkmcnt(6)
    v_fmac_f32 v18, v26, v16
    v_fmac_f32 v19, v26, v17
    v_cndmask_b32 v42, v42, v16, vcc
    v_cndmask_b32 v43, v43, v17, vcc
    v_fmac_f32 v18, v3, v17
    v_fmac_f32 v19, v27, v16
    v_mfma_f32_32x32x16_bf16 v[192:207], v[232:235], a[8:11], v[192:207]
    ds_read_b64_tr_b16 v[244:245], v59 offset:49280
    ds_read_b64_tr_b16 v[246:247], v59 offset:50048
    v_cmp_eq_u32 vcc, 1536, v2
    s_waitcnt lgkmcnt(7)
    v_fmac_f32 v20, v26, v18
    v_mfma_f32_32x32x16_bf16 v[208:223], v[232:235], a[136:139], v[208:223]
    v_fmac_f32 v21, v26, v19
    v_cndmask_b32 v42, v42, v18, vcc
    v_cndmask_b32 v43, v43, v19, vcc
    v_fmac_f32 v20, v3, v19
    v_fmac_f32 v21, v27, v18
    v_cmp_eq_u32 vcc, 1792, v2
    s_waitcnt lgkmcnt(6)
    v_fmac_f32 v22, v26, v20
    v_fmac_f32 v23, v26, v21
    v_cndmask_b32 v42, v42, v20, vcc
    v_cndmask_b32 v43, v43, v21, vcc
    v_fmac_f32 v22, v3, v21
    v_fmac_f32 v23, v27, v20
    v_mov_b32 v28, v22
    v_mov_b32 v30, v23
    buffer_store_dwordx4 v[28:31], v37, s[56:59], 0 offen sc1
    s_waitcnt lgkmcnt(2)
    v_mfma_f32_32x32x16_bf16 v[128:143], v[236:239], a[12:15], v[128:143]
    buffer_load_dwordx4 v54, s[52:55], s66 offen offset:1024 lds
    s_lshl_b32 s3, s70, 4
    v_mfma_f32_32x32x16_bf16 v[144:159], v[236:239], a[140:143], v[144:159]
    buffer_load_dwordx4 v55, s[52:55], s66 offen offset:2048 lds
    v_mfma_f32_32x32x16_bf16 v[160:175], v[240:243], a[12:15], v[160:175]
    s_add_u32 s3, s3, 10551296
    s_waitcnt lgkmcnt(0)
    s_waitcnt vmcnt(15)
    s_barrier
    ds_read_b64_tr_b16 v[224:225], v56 offset:0
    ds_read_b64_tr_b16 v[226:227], v56 offset:768
    v_mfma_f32_32x32x16_bf16 v[176:191], v[240:243], a[140:143], v[176:191]
    ds_read_b64_tr_b16 v[228:229], v56 offset:64
    ds_read_b64_tr_b16 v[230:231], v56 offset:832
    v_mfma_f32_32x32x16_bf16 v[192:207], v[244:247], a[12:15], v[192:207]
    ds_read_b64_tr_b16 v[232:233], v56 offset:128
    ds_read_b64_tr_b16 v[234:235], v56 offset:896
    v_and_b32 v5, 15, v1
    v_mfma_f32_32x32x16_bf16 v[208:223], v[244:247], a[140:143], v[208:223]
    s_mul_i32 s66, s76, 1376
    s_add_u32 s76, s76, 128
    s_and_b32 s76, s76, 1023
    s_add_u32 m0, s75, 122880
    s_add_u32 s66, s66, s74
    v_lshl_add_u32 v6, v5, 4, s3
    v_lshl_add_u32 v37, v2, 6, v6
    s_movk_i32 s19, 8192
    s_waitcnt lgkmcnt(4)
    v_mfma_f32_16x16x32_bf16 v[68:71], v[64:67], v[224:227], v[68:71]
    v_mfma_f32_32x32x16_bf16 v[128:143], v[224:227], a[16:19], v[128:143]
    ds_read_b64_tr_b16 v[236:237], v57 offset:0
    ds_read_b64_tr_b16 v[238:239], v57 offset:768
    v_mfma_f32_32x32x16_bf16 v[144:159], v[224:227], a[144:147], v[144:159]
    buffer_load_dwordx4 v50, s[48:51], s66 offen offset:0 lds
    s_waitcnt lgkmcnt(2)
    v_mfma_f32_16x16x32_bf16 v[72:75], v[64:67], v[228:231], v[72:75]
    v_mfma_f32_32x32x16_bf16 v[160:175], v[228:231], a[16:19], v[160:175]
    ds_read_b64_tr_b16 v[240:241], v57 offset:64
    ds_read_b64_tr_b16 v[242:243], v57 offset:832
    buffer_load_dwordx4 v51, s[48:51], s66 offen offset:1024 lds
    v_mfma_f32_32x32x16_bf16 v[176:191], v[228:231], a[144:147], v[176:191]
    buffer_load_dwordx4 v52, s[48:51], s66 offen offset:2048 lds
    s_add_u32 m0, s75, 125952
    s_nop 0
    v_mfma_f32_16x16x32_bf16 v[76:79], v[64:67], v[232:235], v[76:79]
    v_mfma_f32_32x32x16_bf16 v[192:207], v[232:235], a[16:19], v[192:207]
    ds_read_b64_tr_b16 v[244:245], v57 offset:128
    ds_read_b64_tr_b16 v[246:247], v57 offset:896
    v_mfma_f32_32x32x16_bf16 v[208:223], v[232:235], a[144:147], v[208:223]
    buffer_load_dwordx4 v53, s[52:55], s66 offen offset:0 lds
    s_waitcnt lgkmcnt(2)
    v_mfma_f32_16x16x32_bf16 v[68:71], v[64:67], v[236:239], v[68:71]
    v_mfma_f32_32x32x16_bf16 v[128:143], v[236:239], a[20:23], v[128:143]
    ds_read_b64_tr_b16 v[224:225], v58 offset:0
    ds_read_b64_tr_b16 v[226:227], v58 offset:768
    v_mfma_f32_32x32x16_bf16 v[144:159], v[236:239], a[148:151], v[144:159]
    buffer_load_dwordx4 v54, s[52:55], s66 offen offset:1024 lds
    v_mfma_f32_16x16x32_bf16 v[72:75], v[64:67], v[240:243], v[72:75]
    buffer_load_dwordx4 v55, s[52:55], s66 offen offset:2048 lds
    v_mfma_f32_32x32x16_bf16 v[160:175], v[240:243], a[20:23], v[160:175]
    ds_read_b64_tr_b16 v[228:229], v58 offset:64
    ds_read_b64_tr_b16 v[230:231], v58 offset:832
    s_add_u32 m0, s65, 24576
    s_xor_b32 s66, s84, 0
    v_mfma_f32_32x32x16_bf16 v[176:191], v[240:243], a[148:151], v[176:191]
    buffer_load_dwordx4 v48, s[12:15], s66 offen offset:0 lds
    s_waitcnt lgkmcnt(2)
    v_mfma_f32_16x16x32_bf16 v[76:79], v[64:67], v[244:247], v[76:79]
    v_mfma_f32_32x32x16_bf16 v[192:207], v[244:247], a[20:23], v[192:207]
    ds_read_b64_tr_b16 v[232:233], v58 offset:128
    ds_read_b64_tr_b16 v[234:235], v58 offset:896
    v_mfma_f32_32x32x16_bf16 v[208:223], v[244:247], a[148:151], v[208:223]
    buffer_load_dwordx4 v49, s[12:15], s66 offen offset:1024 lds
    s_add_u32 m0, s65, 26624
    s_xor_b32 s66, s84, 16384
    v_mfma_f32_32x32x16_bf16 v[128:143], v[224:227], a[24:27], v[128:143]
    ds_read_b64_tr_b16 v[236:237], v59 offset:0
    ds_read_b64_tr_b16 v[238:239], v59 offset:768
    v_mfma_f32_32x32x16_bf16 v[144:159], v[224:227], a[152:155], v[144:159]
    buffer_load_dwordx4 v48, s[12:15], s66 offen offset:0 lds
    s_waitcnt lgkmcnt(2)
    v_mfma_f32_32x32x16_bf16 v[160:175], v[228:231], a[24:27], v[160:175]
    ds_read_b64_tr_b16 v[240:241], v59 offset:64
    ds_read_b64_tr_b16 v[242:243], v59 offset:832
    v_mfma_f32_32x32x16_bf16 v[176:191], v[228:231], a[152:155], v[176:191]
    buffer_load_dwordx4 v49, s[12:15], s66 offen offset:1024 lds
    s_add_u32 m0, s65, 40960
    s_xor_b32 s66, s18, 0
    v_mfma_f32_32x32x16_bf16 v[192:207], v[232:235], a[24:27], v[192:207]
    ds_read_b64_tr_b16 v[244:245], v59 offset:128
    ds_read_b64_tr_b16 v[246:247], v59 offset:896
    v_mfma_f32_32x32x16_bf16 v[208:223], v[232:235], a[152:155], v[208:223]
    buffer_load_dwordx4 v48, s[12:15], s66 offen offset:0 lds
    s_waitcnt lgkmcnt(2)
    v_mfma_f32_32x32x16_bf16 v[128:143], v[236:239], a[28:31], v[128:143]
    buffer_load_dwordx4 v49, s[12:15], s66 offen offset:1024 lds
    s_add_u32 m0, s65, 43008
    s_xor_b32 s66, s18, 16384
    v_mfma_f32_32x32x16_bf16 v[144:159], v[236:239], a[156:159], v[144:159]
    buffer_load_dwordx4 v48, s[12:15], s66 offen offset:0 lds
    v_mfma_f32_32x32x16_bf16 v[160:175], v[240:243], a[28:31], v[160:175]
    buffer_load_dwordx4 v49, s[12:15], s66 offen offset:1024 lds
    s_waitcnt lgkmcnt(0)
    s_waitcnt vmcnt(23)
    s_barrier
    ds_read_b64_tr_b16 v[224:225], v56 offset:24576
    ds_read_b64_tr_b16 v[226:227], v56 offset:25344
    v_mfma_f32_32x32x16_bf16 v[176:191], v[240:243], a[156:159], v[176:191]
    ds_read_b64_tr_b16 v[228:229], v56 offset:24640
    ds_read_b64_tr_b16 v[230:231], v56 offset:25408
    v_mfma_f32_32x32x16_bf16 v[192:207], v[244:247], a[28:31], v[192:207]
    ds_read_b64_tr_b16 v[232:233], v56 offset:24704
    ds_read_b64_tr_b16 v[234:235], v56 offset:25472
    v_mfma_f32_32x32x16_bf16 v[208:223], v[244:247], a[156:159], v[208:223]
    s_mul_i32 s66, s76, 1376
    s_add_u32 s76, s76, 128
    s_and_b32 s76, s76, 1023
    s_add_u32 m0, s75, 73728
    s_add_u32 s66, s66, s74
    s_waitcnt lgkmcnt(4)
    v_mfma_f32_16x16x32_bf16 v[68:71], v[64:67], v[224:227], v[68:71]
    v_mfma_f32_32x32x16_bf16 v[128:143], v[224:227], a[32:35], v[128:143]
    ds_read_b64_tr_b16 v[236:237], v57 offset:24576
    ds_read_b64_tr_b16 v[238:239], v57 offset:25344
    v_mfma_f32_32x32x16_bf16 v[144:159], v[224:227], a[160:163], v[144:159]
    buffer_load_dwordx4 v50, s[48:51], s66 offen offset:0 lds
    s_waitcnt lgkmcnt(2)
    v_mfma_f32_16x16x32_bf16 v[72:75], v[64:67], v[228:231], v[72:75]
    buffer_load_dwordx4 v51, s[48:51], s66 offen offset:1024 lds
    v_mfma_f32_32x32x16_bf16 v[160:175], v[228:231], a[32:35], v[160:175]
    ds_read_b64_tr_b16 v[240:241], v57 offset:24640
    ds_read_b64_tr_b16 v[242:243], v57 offset:25408
    v_mfma_f32_32x32x16_bf16 v[176:191], v[228:231], a[160:163], v[176:191]
    v_pk_mul_f32 v[6:7], v[112:113], v[86:87] op_sel:[0,1] op_sel_hi:[1,1]
    v_pk_mul_f32 v[112:113], v[112:113], v[86:87] op_sel_hi:[1,0]
    v_pk_fma_f32 v[112:113], v[96:97], v[86:87], v[112:113] op_sel:[0,1,0] op_sel_hi:[1,1,1]
    v_pk_fma_f32 v[96:97], v[96:97], v[86:87], v[6:7] op_sel_hi:[1,0,1] neg_lo:[0,0,1] neg_hi:[0,0,1]
    v_pk_mul_f32 v[6:7], v[114:115], v[86:87] op_sel:[0,1] op_sel_hi:[1,1]
    v_pk_mul_f32 v[114:115], v[114:115], v[86:87] op_sel_hi:[1,0]
    v_pk_fma_f32 v[114:115], v[98:99], v[86:87], v[114:115] op_sel:[0,1,0] op_sel_hi:[1,1,1]
    v_pk_fma_f32 v[98:99], v[98:99], v[86:87], v[6:7] op_sel_hi:[1,0,1] neg_lo:[0,0,1] neg_hi:[0,0,1]
    v_pk_mul_f32 v[6:7], v[116:117], v[86:87] op_sel:[0,1] op_sel_hi:[1,1]
    v_pk_mul_f32 v[116:117], v[116:117], v[86:87] op_sel_hi:[1,0]
    v_pk_fma_f32 v[116:117], v[100:101], v[86:87], v[116:117] op_sel:[0,1,0] op_sel_hi:[1,1,1]
    v_pk_fma_f32 v[100:101], v[100:101], v[86:87], v[6:7] op_sel_hi:[1,0,1] neg_lo:[0,0,1] neg_hi:[0,0,1]
    v_pk_mul_f32 v[6:7], v[118:119], v[86:87] op_sel:[0,1] op_sel_hi:[1,1]
    v_pk_mul_f32 v[118:119], v[118:119], v[86:87] op_sel_hi:[1,0]
    v_pk_fma_f32 v[118:119], v[102:103], v[86:87], v[118:119] op_sel:[0,1,0] op_sel_hi:[1,1,1]
    v_pk_fma_f32 v[102:103], v[102:103], v[86:87], v[6:7] op_sel_hi:[1,0,1] neg_lo:[0,0,1] neg_hi:[0,0,1]
    v_pk_mul_f32 v[6:7], v[120:121], v[86:87] op_sel:[0,1] op_sel_hi:[1,1]
    v_pk_mul_f32 v[120:121], v[120:121], v[86:87] op_sel_hi:[1,0]
    v_pk_fma_f32 v[120:121], v[104:105], v[86:87], v[120:121] op_sel:[0,1,0] op_sel_hi:[1,1,1]
    v_pk_fma_f32 v[104:105], v[104:105], v[86:87], v[6:7] op_sel_hi:[1,0,1] neg_lo:[0,0,1] neg_hi:[0,0,1]
    v_pk_mul_f32 v[6:7], v[122:123], v[86:87] op_sel:[0,1] op_sel_hi:[1,1]
    v_pk_mul_f32 v[122:123], v[122:123], v[86:87] op_sel_hi:[1,0]
    v_pk_fma_f32 v[122:123], v[106:107], v[86:87], v[122:123] op_sel:[0,1,0] op_sel_hi:[1,1,1]
    v_pk_fma_f32 v[106:107], v[106:107], v[86:87], v[6:7] op_sel_hi:[1,0,1] neg_lo:[0,0,1] neg_hi:[0,0,1]
    v_pk_mul_f32 v[6:7], v[124:125], v[86:87] op_sel:[0,1] op_sel_hi:[1,1]
    v_pk_mul_f32 v[124:125], v[124:125], v[86:87] op_sel_hi:[1,0]
    v_pk_fma_f32 v[124:125], v[108:109], v[86:87], v[124:125] op_sel:[0,1,0] op_sel_hi:[1,1,1]
    v_pk_fma_f32 v[108:109], v[108:109], v[86:87], v[6:7] op_sel_hi:[1,0,1] neg_lo:[0,0,1] neg_hi:[0,0,1]
    v_pk_mul_f32 v[6:7], v[126:127], v[86:87] op_sel:[0,1] op_sel_hi:[1,1]
    v_pk_mul_f32 v[126:127], v[126:127], v[86:87] op_sel_hi:[1,0]
    v_pk_fma_f32 v[126:127], v[110:111], v[86:87], v[126:127] op_sel:[0,1,0] op_sel_hi:[1,1,1]
    v_pk_fma_f32 v[110:111], v[110:111], v[86:87], v[6:7] op_sel_hi:[1,0,1] neg_lo:[0,0,1] neg_hi:[0,0,1]
    buffer_load_dwordx4 v52, s[48:51], s66 offen offset:2048 lds
    s_nop 2
    v_mfma_f32_16x16x32_bf16 v[76:79], v[64:67], v[232:235], v[76:79]
    s_add_u32 m0, s75, 76800
    s_nop 0
    s_mul_i32 s3, s60, 2304
    s_add_u32 s3, s3, 154624
    v_mul_u32_u24 v5, 144, v5
    v_mfma_f32_32x32x16_bf16 v[192:207], v[232:235], a[32:35], v[192:207]
    ds_read_b64_tr_b16 v[244:245], v57 offset:24704
    ds_read_b64_tr_b16 v[246:247], v57 offset:25472
    buffer_load_dwordx4 v53, s[52:55], s66 offen offset:0 lds
    v_mfma_f32_32x32x16_bf16 v[208:223], v[232:235], a[160:163], v[208:223]
    buffer_load_dwordx4 v54, s[52:55], s66 offen offset:1024 lds
    v_bfe_u32 v6, v1, 4, 1
    v_lshl_add_u32 v5, v6, 6, v5
    v_lshrrev_b32 v7, 5, v1
    s_waitcnt lgkmcnt(2)
    v_mfma_f32_16x16x32_bf16 v[68:71], v[64:67], v[236:239], v[68:71]
    v_lshl_add_u32 v5, v7, 5, v5
    s_waitcnt vmcnt(25)
    v_add_u32 v38, s3, v5
    v_bfe_u32 v5, v1, 2, 2
    v_mfma_f32_32x32x16_bf16 v[128:143], v[236:239], a[36:39], v[128:143]
    ds_read_b64_tr_b16 v[224:225], v58 offset:24576
    ds_read_b64_tr_b16 v[226:227], v58 offset:25344
    v_lshl_add_u32 v5, v7, 3, v5
    v_mfma_f32_32x32x16_bf16 v[144:159], v[236:239], a[164:167], v[144:159]
    buffer_load_dwordx4 v55, s[52:55], s66 offen offset:2048 lds
    s_add_u32 m0, s65, 57344
    s_xor_b32 s66, s84, 128
    v_mul_u32_u24 v5, 144, v5
    v_mfma_f32_16x16x32_bf16 v[72:75], v[64:67], v[240:243], v[72:75]
    buffer_load_dwordx4 v48, s[12:15], s66 offen offset:0 lds
    v_mfma_f32_32x32x16_bf16 v[160:175], v[240:243], a[36:39], v[160:175]
    ds_read_b64_tr_b16 v[228:229], v58 offset:24640
    ds_read_b64_tr_b16 v[230:231], v58 offset:25408
    v_lshl_add_u32 v5, v6, 4, v5
    v_mfma_f32_32x32x16_bf16 v[176:191], v[240:243], a[164:167], v[176:191]
    buffer_load_dwordx4 v49, s[12:15], s66 offen offset:1024 lds
    s_add_u32 m0, s65, 59392
    s_xor_b32 s66, s84, 16512
    v_and_b32 v6, 1, v1
    s_waitcnt lgkmcnt(2)
    v_mfma_f32_16x16x32_bf16 v[76:79], v[64:67], v[244:247], v[76:79]
    buffer_load_dwordx4 v[8:11], v37, s[56:59], 0 offen sc1
    buffer_load_dwordx4 v[12:15], v37, s[56:59], s19 offen sc1
    v_lshl_add_u32 v5, v6, 5, v5
    v_bfe_u32 v6, v1, 1, 1
    v_mfma_f32_32x32x16_bf16 v[192:207], v[244:247], a[36:39], v[192:207]
    ds_read_b64_tr_b16 v[232:233], v58 offset:24704
    ds_read_b64_tr_b16 v[234:235], v58 offset:25472
    v_mfma_f32_32x32x16_bf16 v[208:223], v[244:247], a[164:167], v[208:223]
    buffer_load_dwordx4 v48, s[12:15], s66 offen offset:0 lds
    v_lshl_add_u32 v5, v6, 3, v5
    v_mfma_f32_32x32x16_bf16 v[128:143], v[224:227], a[40:43], v[128:143]
    ds_read_b64_tr_b16 v[236:237], v59 offset:24576
    ds_read_b64_tr_b16 v[238:239], v59 offset:25344
    buffer_load_dwordx4 v49, s[12:15], s66 offen offset:1024 lds
    v_mfma_f32_32x32x16_bf16 v[144:159], v[224:227], a[168:171], v[144:159]
    s_waitcnt vmcnt(16)
    ds_read_b128 a[0:3], v44 offset:24576
    ds_read_b128 a[4:7], v45 offset:24576
    v_add_u32 v39, s3, v5
    s_lshl_b32 s63, s61, 1
    s_add_u32 s83, s83, s63
    s_waitcnt lgkmcnt(4)
    v_mfma_f32_32x32x16_bf16 v[160:175], v[228:231], a[40:43], v[160:175]
    ds_read_b64_tr_b16 v[240:241], v59 offset:24640
    ds_read_b64_tr_b16 v[242:243], v59 offset:25408
    v_mfma_f32_32x32x16_bf16 v[176:191], v[228:231], a[168:171], v[176:191]
    ds_read_b128 a[8:11], v46 offset:24576
    ds_read_b128 a[12:15], v47 offset:24576
    s_mul_i32 s3, s83, 307200
    s_lshl_b32 s63, s82, 10
    v_mfma_f32_32x32x16_bf16 v[192:207], v[232:235], a[40:43], v[192:207]
    ds_read_b64_tr_b16 v[244:245], v59 offset:24704
    ds_read_b64_tr_b16 v[246:247], v59 offset:25472
    s_add_u32 s3, s3, s63
    v_mfma_f32_32x32x16_bf16 v[208:223], v[232:235], a[168:171], v[208:223]
    s_waitcnt lgkmcnt(2)
    s_add_u32 m0, s65, 24576
    s_xor_b32 s66, s18, 128
    buffer_load_dwordx4 v48, s[12:15], s66 offen offset:0 lds
    v_mfma_f32_32x32x16_bf16 v[128:143], v[236:239], a[44:47], v[128:143]
    buffer_load_dwordx4 v49, s[12:15], s66 offen offset:1024 lds
    s_add_u32 m0, s65, 26624
    s_xor_b32 s66, s18, 16512
    v_lshl_add_u32 v36, v1, 4, s3
    s_lshl_b32 s6, s70, 7
    s_add_u32 s7, s6, 65536
    s_lshl_b32 s3, s83, 9
    v_mfma_f32_32x32x16_bf16 v[144:159], v[236:239], a[172:175], v[144:159]
    buffer_load_dwordx4 v48, s[12:15], s66 offen offset:0 lds
    s_lshr_b32 s63, s70, 2
    s_add_u32 s3, s3, s63
    s_add_u32 s3, s3, 10813440
    v_mfma_f32_32x32x16_bf16 v[160:175], v[240:243], a[44:47], v[160:175]
    buffer_load_dwordx4 v49, s[12:15], s66 offen offset:1024 lds
    s_waitcnt lgkmcnt(0)
    s_barrier
    ds_read_b64_tr_b16 v[224:225], v60 offset:0
    ds_read_b64_tr_b16 v[226:227], v60 offset:768
    v_mfma_f32_32x32x16_bf16 v[176:191], v[240:243], a[172:175], v[176:191]
    ds_read_b64_tr_b16 v[228:229], v60 offset:64
    ds_read_b64_tr_b16 v[230:231], v60 offset:832
    v_mfma_f32_32x32x16_bf16 v[192:207], v[244:247], a[44:47], v[192:207]
    ds_read_b64_tr_b16 v[232:233], v60 offset:128
    ds_read_b64_tr_b16 v[234:235], v60 offset:896
    v_mfma_f32_32x32x16_bf16 v[208:223], v[244:247], a[172:175], v[208:223]
    s_mul_i32 s66, s76, 1376
    s_add_u32 s76, s76, 128
    s_and_b32 s76, s76, 1023
    s_add_u32 m0, s75, 98304
    s_add_u32 s66, s66, s74
    buffer_load_dwordx4 v50, s[48:51], s66 offen offset:0 lds
    s_waitcnt lgkmcnt(4)
    v_mfma_f32_16x16x32_bf16 v[68:71], v[64:67], v[224:227], v[68:71]
    v_mov_b32 v5, s3
    v_mov_b32 v6, 2147483632
    v_cmp_eq_u32 vcc, 0, v1
    v_mfma_f32_32x32x16_bf16 v[128:143], v[224:227], a[48:51], v[128:143]
    ds_read_b64_tr_b16 v[236:237], v61 offset:0
    ds_read_b64_tr_b16 v[238:239], v61 offset:768
    v_mfma_f32_32x32x16_bf16 v[144:159], v[224:227], a[176:179], v[144:159]
    buffer_load_dwordx4 v51, s[48:51], s66 offen offset:1024 lds
    v_mov_b32 v41, s71
    v_cndmask_b32 v40, v6, v5, vcc
    s_waitcnt lgkmcnt(2)
    v_mfma_f32_16x16x32_bf16 v[72:75], v[64:67], v[228:231], v[72:75]
    v_mfma_f32_32x32x16_bf16 v[160:175], v[228:231], a[48:51], v[160:175]
    ds_read_b64_tr_b16 v[240:241], v61 offset:64
    ds_read_b64_tr_b16 v[242:243], v61 offset:832
    v_mfma_f32_32x32x16_bf16 v[176:191], v[228:231], a[176:179], v[176:191]
    buffer_load_dwordx4 v52, s[48:51], s66 offen offset:2048 lds
    s_add_u32 m0, s75, 101376
    s_nop 0
    buffer_load_dwordx4 v53, s[52:55], s66 offen offset:0 lds
    v_mfma_f32_16x16x32_bf16 v[76:79], v[64:67], v[232:235], v[76:79]
    buffer_load_dwordx4 v54, s[52:55], s66 offen offset:1024 lds
    v_mfma_f32_32x32x16_bf16 v[192:207], v[232:235], a[48:51], v[192:207]
    ds_read_b64_tr_b16 v[244:245], v61 offset:128
    ds_read_b64_tr_b16 v[246:247], v61 offset:896
    v_mfma_f32_32x32x16_bf16 v[208:223], v[232:235], a[176:179], v[208:223]
parallel_sum__ssm_conv_s5__glu_gated_bilinear__prompt_kernel_chkA:
    s_waitcnt vmcnt(12)
    v_cmp_ne_u32 vcc, s71, v9
    v_cmp_ne_u32 s[100:101], s71, v11
    s_nop 1
    s_or_b64 vcc, vcc, s[100:101]
    s_and_b64 s[94:95], vcc, s[96:97]
    s_waitcnt vmcnt(11)
    v_cmp_ne_u32 vcc, s71, v13
    v_cmp_ne_u32 s[100:101], s71, v15
    s_nop 1
    s_or_b64 vcc, vcc, s[100:101]
    s_and_b64 vcc, vcc, s[98:99]
    s_or_b64 s[94:95], s[94:95], vcc
    s_cbranch_scc1 parallel_sum__ssm_conv_s5__glu_gated_bilinear__prompt_kernel_slowA
parallel_sum__ssm_conv_s5__glu_gated_bilinear__prompt_kernel_goA:
    buffer_load_dwordx4 v55, s[52:55], s66 offen offset:2048 lds
    v_cndmask_b32 v8, 0, v8, s[96:97]
    v_cndmask_b32 v10, 0, v10, s[96:97]
    v_cndmask_b32 v12, 0, v12, s[98:99]
    v_cndmask_b32 v14, 0, v14, s[98:99]
    s_waitcnt lgkmcnt(2)
    v_mfma_f32_16x16x32_bf16 v[68:71], v[64:67], v[236:239], v[68:71]
    v_mul_f32 v28, v88, v8
    v_mul_f32 v29, v88, v10
    v_fma_f32 v28, -v89, v10, v28
    v_fmac_f32 v29, v89, v8
    v_fma_f32 v30, v90, v12, v28
    v_fma_f32 v31, v90, v14, v29
    v_fma_f32 v30, -v91, v14, v30
    v_fmac_f32 v31, v91, v12
    v_mfma_f32_32x32x16_bf16 v[128:143], v[236:239], a[52:55], v[128:143]
    ds_read_b64_tr_b16 v[224:225], v62 offset:0
    ds_read_b64_tr_b16 v[226:227], v62 offset:768
    ds_write_b64 v252, v[30:31] offset:2048
    v_mfma_f32_32x32x16_bf16 v[144:159], v[236:239], a[180:183], v[144:159]
    ds_read_b128 a[128:131], v44 offset:40960
    s_waitcnt lgkmcnt(1)
    s_barrier
    ds_read_b128 a[132:135], v45 offset:40960
    ds_read_b128 a[136:139], v46 offset:40960
    ds_read_b64 v[8:9], v253 offset:2048
    ds_read_b128 a[140:143], v47 offset:40960
    v_mfma_f32_16x16x32_bf16 v[72:75], v[64:67], v[240:243], v[72:75]
    ds_read_b64 v[10:11], v253 offset:2304
    ds_read_b64 v[12:13], v253 offset:2560
    ds_read_b64 v[14:15], v253 offset:2816
    v_mfma_f32_32x32x16_bf16 v[160:175], v[240:243], a[52:55], v[160:175]
    ds_read_b64_tr_b16 v[228:229], v62 offset:64
    ds_read_b64_tr_b16 v[230:231], v62 offset:832
    ds_read_b64 v[16:17], v253 offset:3072
    v_mfma_f32_32x32x16_bf16 v[176:191], v[240:243], a[180:183], v[176:191]
    ds_read_b64 v[18:19], v253 offset:3328
    s_waitcnt vmcnt(10)
    ds_read_b128 a[16:19], v44 offset:57344
    ds_read_b64 v[20:21], v253 offset:3584
    ds_read_b128 a[20:23], v45 offset:57344
    ds_read_b64 v[22:23], v253 offset:3840
    ds_read_b128 a[24:27], v46 offset:57344
    v_xor_b32 v37, 1024, v36
    v_mfma_f32_16x16x32_bf16 v[76:79], v[64:67], v[244:247], v[76:79]
    ds_read_b128 a[28:31], v47 offset:57344
    v_mfma_f32_32x32x16_bf16 v[192:207], v[244:247], a[52:55], v[192:207]
    ds_read_b64_tr_b16 v[232:233], v62 offset:128
    ds_read_b64_tr_b16 v[234:235], v62 offset:896
    v_mfma_f32_32x32x16_bf16 v[208:223], v[244:247], a[180:183], v[208:223]
    s_waitcnt lgkmcnt(15)
    s_add_u32 m0, s65, 40960
    s_xor_b32 s66, s84, 256
    buffer_load_dwordx4 v48, s[12:15], s66 offen offset:0 lds
    s_waitcnt lgkmcnt(14)
    v_add_f32 v8, v8, v10
    v_add_f32 v9, v9, v11
    s_waitcnt lgkmcnt(13)
    v_add_f32 v8, v8, v12
    v_add_f32 v9, v9, v13
    s_waitcnt lgkmcnt(12)
    v_add_f32 v8, v8, v14
    v_add_f32 v9, v9, v15
    s_waitcnt lgkmcnt(9)
    v_add_f32 v8, v8, v16
    v_add_f32 v9, v9, v17
    v_mfma_f32_32x32x16_bf16 v[128:143], v[224:227], a[56:59], v[128:143]
    ds_read_b64_tr_b16 v[236:237], v63 offset:0
    ds_read_b64_tr_b16 v[238:239], v63 offset:768
    s_waitcnt lgkmcnt(10)
    v_add_f32 v8, v8, v18
    v_add_f32 v9, v9, v19
    v_mfma_f32_32x32x16_bf16 v[144:159], v[224:227], a[184:187], v[144:159]
    s_waitcnt lgkmcnt(8)
    v_add_f32 v8, v8, v20
    v_add_f32 v9, v9, v21
    buffer_load_dwordx4 v49, s[12:15], s66 offen offset:1024 lds
    s_waitcnt lgkmcnt(6)
    v_add_f32 v8, v8, v22
    v_add_f32 v9, v9, v23
    v_fma_f32 v10, v84, v8, v42
    v_fma_f32 v11, v84, v9, v43
    v_fma_f32 v10, -v85, v9, v10
    s_add_u32 m0, s65, 43008
    s_xor_b32 s66, s84, 16640
    v_fmac_f32 v11, v85, v8
    v_fma_f32 v12, v82, v10, v24
    v_fma_f32 v13, v82, v11, v25
    v_fma_f32 v12, -v83, v11, v12
    v_fmac_f32 v13, v83, v10
    v_mul_f32 v28, v86, v10
    v_mfma_f32_32x32x16_bf16 v[160:175], v[228:231], a[56:59], v[160:175]
    ds_read_b64_tr_b16 v[240:241], v63 offset:64
    ds_read_b64_tr_b16 v[242:243], v63 offset:832
    v_mul_f32 v30, v86, v11
    v_fma_f32 v28, -v87, v11, v28
    v_mfma_f32_32x32x16_bf16 v[176:191], v[228:231], a[184:187], v[176:191]
    buffer_load_dwordx4 v48, s[12:15], s66 offen offset:0 lds
    v_fmac_f32 v30, v87, v10
    v_mul_f32 v29, v86, v12
    v_mul_f32 v31, v86, v13
    v_fma_f32 v29, -v87, v13, v29
    v_fmac_f32 v31, v87, v12
    buffer_load_dwordx4 v49, s[12:15], s66 offen offset:1024 lds
    s_waitcnt lgkmcnt(2)
    v_mfma_f32_32x32x16_bf16 v[192:207], v[232:235], a[56:59], v[192:207]
    ds_read_b64_tr_b16 v[244:245], v63 offset:128
    ds_read_b64_tr_b16 v[246:247], v63 offset:896
    v_mfma_f32_32x32x16_bf16 v[208:223], v[232:235], a[184:187], v[208:223]
    s_add_u32 m0, s65, 57344
    s_xor_b32 s66, s18, 256
    buffer_load_dwordx4 v48, s[12:15], s66 offen offset:0 lds
    buffer_load_dwordx4 v49, s[12:15], s66 offen offset:1024 lds
    v_mfma_f32_32x32x16_bf16 v[128:143], v[236:239], a[60:63], v[128:143]
    v_pk_fma_f32 v[96:97], v[28:29], v[80:81], v[96:97] op_sel_hi:[1,0,1]
    v_pk_fma_f32 v[112:113], v[30:31], v[80:81], v[112:113] op_sel_hi:[1,0,1]
    v_pk_fma_f32 v[96:97], v[30:31], v[80:81], v[96:97] op_sel:[0,1,0] op_sel_hi:[1,1,1] neg_lo:[1,0,0] neg_hi:[1,0,0]
    v_pk_fma_f32 v[112:113], v[28:29], v[80:81], v[112:113] op_sel:[0,1,0] op_sel_hi:[1,1,1]
    v_pk_fma_f32 v[98:99], v[96:97], v[80:81], v[98:99] op_sel_hi:[1,0,1]
    v_pk_fma_f32 v[114:115], v[112:113], v[80:81], v[114:115] op_sel_hi:[1,0,1]
    v_pk_fma_f32 v[98:99], v[112:113], v[80:81], v[98:99] op_sel:[0,1,0] op_sel_hi:[1,1,1] neg_lo:[1,0,0] neg_hi:[1,0,0]
    v_pk_fma_f32 v[114:115], v[96:97], v[80:81], v[114:115] op_sel:[0,1,0] op_sel_hi:[1,1,1]
    v_pk_fma_f32 v[100:101], v[98:99], v[80:81], v[100:101] op_sel_hi:[1,0,1]
    v_pk_fma_f32 v[116:117], v[114:115], v[80:81], v[116:117] op_sel_hi:[1,0,1]
    v_pk_fma_f32 v[100:101], v[114:115], v[80:81], v[100:101] op_sel:[0,1,0] op_sel_hi:[1,1,1] neg_lo:[1,0,0] neg_hi:[1,0,0]
    v_pk_fma_f32 v[116:117], v[98:99], v[80:81], v[116:117] op_sel:[0,1,0] op_sel_hi:[1,1,1]
    v_pk_fma_f32 v[102:103], v[100:101], v[80:81], v[102:103] op_sel_hi:[1,0,1]
    v_pk_fma_f32 v[118:119], v[116:117], v[80:81], v[118:119] op_sel_hi:[1,0,1]
    v_pk_fma_f32 v[102:103], v[116:117], v[80:81], v[102:103] op_sel:[0,1,0] op_sel_hi:[1,1,1] neg_lo:[1,0,0] neg_hi:[1,0,0]
    v_pk_fma_f32 v[118:119], v[100:101], v[80:81], v[118:119] op_sel:[0,1,0] op_sel_hi:[1,1,1]
    v_pk_fma_f32 v[104:105], v[102:103], v[80:81], v[104:105] op_sel_hi:[1,0,1]
    v_pk_fma_f32 v[120:121], v[118:119], v[80:81], v[120:121] op_sel_hi:[1,0,1]
    v_pk_fma_f32 v[104:105], v[118:119], v[80:81], v[104:105] op_sel:[0,1,0] op_sel_hi:[1,1,1] neg_lo:[1,0,0] neg_hi:[1,0,0]
    v_pk_fma_f32 v[120:121], v[102:103], v[80:81], v[120:121] op_sel:[0,1,0] op_sel_hi:[1,1,1]
    v_pk_fma_f32 v[106:107], v[104:105], v[80:81], v[106:107] op_sel_hi:[1,0,1]
    v_pk_fma_f32 v[122:123], v[120:121], v[80:81], v[122:123] op_sel_hi:[1,0,1]
    v_pk_fma_f32 v[106:107], v[120:121], v[80:81], v[106:107] op_sel:[0,1,0] op_sel_hi:[1,1,1] neg_lo:[1,0,0] neg_hi:[1,0,0]
    v_pk_fma_f32 v[122:123], v[104:105], v[80:81], v[122:123] op_sel:[0,1,0] op_sel_hi:[1,1,1]
    v_pk_fma_f32 v[108:109], v[106:107], v[80:81], v[108:109] op_sel_hi:[1,0,1]
    v_pk_fma_f32 v[124:125], v[122:123], v[80:81], v[124:125] op_sel_hi:[1,0,1]
    v_pk_fma_f32 v[108:109], v[122:123], v[80:81], v[108:109] op_sel:[0,1,0] op_sel_hi:[1,1,1] neg_lo:[1,0,0] neg_hi:[1,0,0]
    v_pk_fma_f32 v[124:125], v[106:107], v[80:81], v[124:125] op_sel:[0,1,0] op_sel_hi:[1,1,1]
    v_pk_fma_f32 v[110:111], v[108:109], v[80:81], v[110:111] op_sel_hi:[1,0,1]
    v_pk_fma_f32 v[126:127], v[124:125], v[80:81], v[126:127] op_sel_hi:[1,0,1]
    v_pk_fma_f32 v[110:111], v[124:125], v[80:81], v[110:111] op_sel:[0,1,0] op_sel_hi:[1,1,1] neg_lo:[1,0,0] neg_hi:[1,0,0]
    v_pk_fma_f32 v[126:127], v[108:109], v[80:81], v[126:127] op_sel:[0,1,0] op_sel_hi:[1,1,1]
    s_nop 3
    v_mfma_f32_32x32x16_bf16 v[144:159], v[236:239], a[188:191], v[144:159]
    v_cvt_pk_bf16_f32 v8, v96, v97
    v_cvt_pk_bf16_f32 v16, -v112, -v113
    v_cvt_pk_bf16_f32 v9, v98, v99
    v_cvt_pk_bf16_f32 v17, -v114, -v115
    v_cvt_pk_bf16_f32 v10, v100, v101
    v_cvt_pk_bf16_f32 v18, -v116, -v117
    s_add_u32 m0, s65, 59392
    s_xor_b32 s66, s18, 16640
    v_cvt_pk_bf16_f32 v11, v102, v103
    buffer_load_dwordx4 v48, s[12:15], s66 offen offset:0 lds
    v_cvt_pk_bf16_f32 v19, -v118, -v119
    v_cvt_pk_bf16_f32 v12, v104, v105
    v_cvt_pk_bf16_f32 v20, -v120, -v121
    v_cvt_pk_bf16_f32 v13, v106, v107
    s_waitcnt lgkmcnt(0)
    v_mfma_f32_32x32x16_bf16 v[160:175], v[240:243], a[60:63], v[160:175]
    v_cvt_pk_bf16_f32 v21, -v122, -v123
    buffer_load_dwordx4 v49, s[12:15], s66 offen offset:1024 lds
    v_cvt_pk_bf16_f32 v14, v108, v109
    v_cvt_pk_bf16_f32 v22, -v124, -v125
    v_cvt_pk_bf16_f32 v15, v110, v111
    v_cvt_pk_bf16_f32 v23, -v126, -v127
    s_barrier
    ds_read_b64_tr_b16 v[224:225], v56 offset:49152
    ds_read_b64_tr_b16 v[226:227], v56 offset:49920
    v_mfma_f32_32x32x16_bf16 v[176:191], v[240:243], a[188:191], v[176:191]
    ds_read_b64_tr_b16 v[228:229], v56 offset:49216
    ds_read_b64_tr_b16 v[230:231], v56 offset:49984
    ds_write_b128 v38, v[8:11] offset:0
    ds_write_b128 v38, v[12:15] offset:16
    v_mfma_f32_32x32x16_bf16 v[192:207], v[244:247], a[60:63], v[192:207]
    ds_read_b64_tr_b16 v[232:233], v56 offset:49280
    ds_read_b64_tr_b16 v[234:235], v56 offset:50048
    ds_read_b64_tr_b16 v[96:97], v39 offset:0
    ds_read_b64_tr_b16 v[98:99], v39 offset:576
    v_mfma_f32_32x32x16_bf16 v[208:223], v[244:247], a[188:191], v[208:223]
    ds_read_b64_tr_b16 v[100:101], v39 offset:64
    ds_read_b64_tr_b16 v[102:103], v39 offset:640
    s_mul_i32 s66, s76, 1376
    s_add_u32 s76, s76, 128
    s_and_b32 s76, s76, 1023
    s_add_u32 m0, s75, 0
    s_add_u32 s66, s66, s74
    s_waitcnt lgkmcnt(10)
    v_mfma_f32_16x16x32_bf16 v[68:71], v[64:67], v[224:227], v[68:71]
    ds_write_b128 v38, v[16:19] offset:0
    ds_write_b128 v38, v[20:23] offset:16
    v_mfma_f32_32x32x16_bf16 v[128:143], v[224:227], a[64:67], v[128:143]
    ds_read_b64_tr_b16 v[236:237], v57 offset:49152
    ds_read_b64_tr_b16 v[238:239], v57 offset:49920
    ds_read_b64_tr_b16 v[104:105], v39 offset:0
    ds_read_b64_tr_b16 v[106:107], v39 offset:576
    v_mfma_f32_32x32x16_bf16 v[144:159], v[224:227], a[192:195], v[144:159]
    buffer_load_dwordx4 v50, s[48:51], s66 offen offset:0 lds
    ds_read_b64_tr_b16 v[108:109], v39 offset:64
    ds_read_b64_tr_b16 v[110:111], v39 offset:640
    s_waitcnt lgkmcnt(10)
    v_mfma_f32_16x16x32_bf16 v[72:75], v[64:67], v[228:231], v[72:75]
    v_mfma_f32_32x32x16_bf16 v[160:175], v[228:231], a[64:67], v[160:175]
    ds_read_b64_tr_b16 v[240:241], v57 offset:49216
    ds_read_b64_tr_b16 v[242:243], v57 offset:49984
    v_mfma_f32_32x32x16_bf16 v[176:191], v[228:231], a[192:195], v[176:191]
    buffer_load_dwordx4 v51, s[48:51], s66 offen offset:1024 lds
    buffer_store_dwordx4 v[96:99], v36, s[56:59], s6 offen sc1
    v_mfma_f32_16x16x32_bf16 v[76:79], v[64:67], v[232:235], v[76:79]
    v_mfma_f32_32x32x16_bf16 v[192:207], v[232:235], a[64:67], v[192:207]
    ds_read_b64_tr_b16 v[244:245], v57 offset:49280
    ds_read_b64_tr_b16 v[246:247], v57 offset:50048
    s_waitcnt lgkmcnt(12)
    buffer_store_dwordx4 v[100:103], v37, s[56:59], s6 offen sc1
    v_mfma_f32_32x32x16_bf16 v[208:223], v[232:235], a[192:195], v[208:223]
    buffer_load_dwordx4 v52, s[48:51], s66 offen offset:2048 lds
    s_waitcnt lgkmcnt(2)
    v_mfma_f32_16x16x32_bf16 v[68:71], v[64:67], v[236:239], v[68:71]
    buffer_store_dwordx4 v[104:107], v36, s[56:59], s7 offen sc1
    s_add_u32 m0, s75, 3072
    s_nop 0
    v_mfma_f32_32x32x16_bf16 v[128:143], v[236:239], a[68:71], v[128:143]
    ds_read_b64_tr_b16 v[224:225], v58 offset:49152
    ds_read_b64_tr_b16 v[226:227], v58 offset:49920
    buffer_load_dwordx4 v53, s[52:55], s66 offen offset:0 lds
    v_mfma_f32_32x32x16_bf16 v[144:159], v[236:239], a[196:199], v[144:159]
    buffer_store_dwordx4 v[108:111], v37, s[56:59], s7 offen sc1
    buffer_load_dwordx4 v54, s[52:55], s66 offen offset:1024 lds
    v_mfma_f32_16x16x32_bf16 v[72:75], v[64:67], v[240:243], v[72:75]
    v_mfma_f32_32x32x16_bf16 v[160:175], v[240:243], a[68:71], v[160:175]
    ds_read_b64_tr_b16 v[228:229], v58 offset:49216
    ds_read_b64_tr_b16 v[230:231], v58 offset:49984
    v_mfma_f32_32x32x16_bf16 v[176:191], v[240:243], a[196:199], v[176:191]
    buffer_load_dwordx4 v55, s[52:55], s66 offen offset:2048 lds
    s_waitcnt lgkmcnt(2)
    v_mfma_f32_16x16x32_bf16 v[76:79], v[64:67], v[244:247], v[76:79]
    s_lshl_b32 s3, s80, 9
    s_add_u32 s3, s3, 10813440
    v_and_b32 v2, 31, v1
    v_mfma_f32_32x32x16_bf16 v[192:207], v[244:247], a[68:71], v[192:207]
    ds_read_b64_tr_b16 v[232:233], v58 offset:49280
    ds_read_b64_tr_b16 v[234:235], v58 offset:50048
    v_lshl_add_u32 v8, v2, 2, s3
    v_mfma_f32_32x32x16_bf16 v[208:223], v[244:247], a[196:199], v[208:223]
    s_waitcnt vmcnt(24)
    ds_read_b128 a[144:147], v44 offset:24576
    ds_read_b128 a[148:151], v45 offset:24576
    v_mfma_f32_32x32x16_bf16 v[128:143], v[224:227], a[72:75], v[128:143]
    ds_read_b64_tr_b16 v[236:237], v59 offset:49152
    ds_read_b64_tr_b16 v[238:239], v59 offset:49920
    v_add_u32 v11, s89, v36
    v_mfma_f32_32x32x16_bf16 v[144:159], v[224:227], a[200:203], v[144:159]
    ds_read_b128 a[152:155], v46 offset:24576
    ds_read_b128 a[156:159], v47 offset:24576
    v_add_u32 v12, s89, v37
    s_waitcnt lgkmcnt(6)
    v_mfma_f32_32x32x16_bf16 v[160:175], v[228:231], a[72:75], v[160:175]
    ds_read_b64_tr_b16 v[240:241], v59 offset:49216
    ds_read_b64_tr_b16 v[242:243], v59 offset:49984
    v_mfma_f32_32x32x16_bf16 v[176:191], v[228:231], a[200:203], v[176:191]
    v_lshlrev_b32 v17, 4, v1
    s_lshl_b32 s3, s82, 10
    v_mfma_f32_32x32x16_bf16 v[192:207], v[232:235], a[72:75], v[192:207]
    ds_read_b64_tr_b16 v[244:245], v59 offset:49280
    ds_read_b64_tr_b16 v[246:247], v59 offset:50048
    v_mfma_f32_32x32x16_bf16 v[208:223], v[232:235], a[200:203], v[208:223]
    s_waitcnt lgkmcnt(4)
    s_add_u32 m0, s65, 24576
    s_xor_b32 s66, s84, 384
    buffer_load_dwordx4 v48, s[12:15], s66 offen offset:0 lds
    v_mfma_f32_32x32x16_bf16 v[128:143], v[236:239], a[76:79], v[128:143]
    buffer_load_dwordx4 v49, s[12:15], s66 offen offset:1024 lds
    s_add_u32 m0, s65, 26624
    s_xor_b32 s66, s84, 16768
    s_add_u32 s3, s3, 147456
    v_mfma_f32_32x32x16_bf16 v[144:159], v[236:239], a[204:207], v[144:159]
    buffer_load_dwordx4 v48, s[12:15], s66 offen offset:0 lds
    v_add_u32 v13, s3, v17
    s_waitcnt lgkmcnt(0)
    v_mfma_f32_32x32x16_bf16 v[160:175], v[240:243], a[76:79], v[160:175]
    buffer_load_dwordx4 v49, s[12:15], s66 offen offset:1024 lds
    s_barrier
    ds_read_b64_tr_b16 v[224:225], v56 offset:0
    ds_read_b64_tr_b16 v[226:227], v56 offset:768
    v_mfma_f32_32x32x16_bf16 v[176:191], v[240:243], a[204:207], v[176:191]
    ds_read_b64_tr_b16 v[228:229], v57 offset:0
    ds_read_b64_tr_b16 v[230:231], v57 offset:768
    v_mfma_f32_32x32x16_bf16 v[192:207], v[244:247], a[76:79], v[192:207]
    s_waitcnt vmcnt(22)
    s_barrier
    ds_read_b64_tr_b16 v[232:233], v56 offset:24576
    ds_read_b64_tr_b16 v[234:235], v56 offset:25344
    v_mfma_f32_32x32x16_bf16 v[208:223], v[244:247], a[204:207], v[208:223]
    v_bfe_u32 v51, v1, 4, 1
    v_lshlrev_b32 v51, 2, v51
    v_xor_b32 v51, v51, v1
    v_and_b32 v51, 7, v51
    v_lshlrev_b32 v51, 4, v51
    v_lshrrev_b32 v50, 3, v1
    v_lshl_add_u32 v50, v50, 10, v51
    v_add_u32 v51, 7168, v50
    s_waitcnt lgkmcnt(4)
    v_mfma_f32_16x16x32_bf16 v[68:71], v[64:67], v[224:227], v[68:71]
    v_mfma_f32_32x32x16_bf16 v[128:143], v[224:227], a[80:83], v[128:143]
    ds_read_b64_tr_b16 v[236:237], v57 offset:24576
    ds_read_b64_tr_b16 v[238:239], v57 offset:25344
    v_mfma_f32_32x32x16_bf16 v[144:159], v[224:227], a[208:211], v[144:159]
    s_waitcnt vmcnt(18)
    ds_read_b128 a[32:35], v44 offset:40960
    ds_read_b128 a[36:39], v45 offset:40960
    s_waitcnt lgkmcnt(4)
    v_mfma_f32_16x16x32_bf16 v[68:71], v[64:67], v[228:231], v[68:71]
    ds_read_b128 a[40:43], v46 offset:40960
    v_mfma_f32_32x32x16_bf16 v[128:143], v[228:231], a[84:87], v[128:143]
    s_waitcnt vmcnt(4)
    s_barrier
    ds_read_b64_tr_b16 v[240:241], v60 offset:0
    ds_read_b64_tr_b16 v[242:243], v60 offset:768
    v_mfma_f32_32x32x16_bf16 v[144:159], v[228:231], a[212:215], v[144:159]
    ds_read_b128 a[44:47], v47 offset:40960
    ds_read_b128 a[160:163], v44 offset:57344
    v_mfma_f32_16x16x32_bf16 v[68:71], v[64:67], v[232:235], v[68:71]
    ds_read_b128 a[164:167], v45 offset:57344
    v_mfma_f32_32x32x16_bf16 v[128:143], v[232:235], a[96:99], v[128:143]
    ds_read_b64_tr_b16 v[244:245], v61 offset:0
    ds_read_b64_tr_b16 v[246:247], v61 offset:768
    v_mfma_f32_32x32x16_bf16 v[144:159], v[232:235], a[224:227], v[144:159]
    ds_read_b128 a[168:171], v46 offset:57344
    ds_read_b128 a[172:175], v47 offset:57344
    s_waitcnt lgkmcnt(7)
    v_mfma_f32_16x16x32_bf16 v[68:71], v[64:67], v[236:239], v[68:71]
    v_mfma_f32_32x32x16_bf16 v[128:143], v[236:239], a[100:103], v[128:143]
    ds_read_b64_tr_b16 v[224:225], v58 offset:0
    ds_read_b64_tr_b16 v[226:227], v58 offset:768
    v_mfma_f32_32x32x16_bf16 v[144:159], v[236:239], a[228:231], v[144:159]
    s_waitcnt lgkmcnt(8)
    s_add_u32 m0, s65, 40960
    s_xor_b32 s66, s18, 384
    buffer_load_dwordx4 v48, s[12:15], s66 offen offset:0 lds
    v_mfma_f32_16x16x32_bf16 v[68:71], v[64:67], v[240:243], v[68:71]
    buffer_load_dwordx4 v49, s[12:15], s66 offen offset:1024 lds
    v_mfma_f32_32x32x16_bf16 v[128:143], v[240:243], a[112:115], v[128:143]
    ds_read_b64_tr_b16 v[228:229], v59 offset:0
    ds_read_b64_tr_b16 v[230:231], v59 offset:768
    buffer_store_dword v41, v40, s[56:59], 0 offen sc1
    v_mfma_f32_32x32x16_bf16 v[144:159], v[240:243], a[240:243], v[144:159]
    s_add_u32 m0, s65, 43008
    s_xor_b32 s66, s18, 16768
    buffer_load_dwordx4 v48, s[12:15], s66 offen offset:0 lds
    s_waitcnt lgkmcnt(2)
    v_mfma_f32_16x16x32_bf16 v[68:71], v[64:67], v[244:247], v[68:71]
    v_mfma_f32_32x32x16_bf16 v[128:143], v[244:247], a[116:119], v[128:143]
    ds_read_b64_tr_b16 v[232:233], v58 offset:24576
    ds_read_b64_tr_b16 v[234:235], v58 offset:25344
    v_mfma_f32_32x32x16_bf16 v[144:159], v[244:247], a[244:247], v[144:159]
    buffer_load_dwordx4 v49, s[12:15], s66 offen offset:1024 lds
    v_mfma_f32_32x32x16_bf16 v[128:143], v[224:227], a[88:91], v[128:143]
    ds_read_b64_tr_b16 v[236:237], v59 offset:24576
    ds_read_b64_tr_b16 v[238:239], v59 offset:25344
    v_mfma_f32_32x32x16_bf16 v[144:159], v[224:227], a[216:219], v[144:159]
    s_lshl_b32 s66, s22, 3
    s_add_u32 s66, s66, s85
    s_add_u32 m0, s65, 122880
    s_add_u32 s66, s66, 0
    buffer_load_dwordx4 v50, s[24:27], s66 offen offset:0 lds
    buffer_load_dwordx4 v51, s[24:27], s66 offen offset:1024 lds
    v_cvt_pk_bf16_f32 v2, v68, v68
    s_waitcnt lgkmcnt(2)
    v_mfma_f32_32x32x16_bf16 v[128:143], v[228:231], a[92:95], v[128:143]
    ds_read_b64_tr_b16 v[240:241], v62 offset:0
    ds_read_b64_tr_b16 v[242:243], v62 offset:768
    v_and_b32 v2, s79, v2
    v_sub_f32 v68, v68, v2
    v_mfma_f32_32x32x16_bf16 v[144:159], v[228:231], a[220:223], v[144:159]
    v_cvt_pk_bf16_f32 v68, v2, v68
    ds_write_b128 v254, v[68:71] offset:0
    s_add_u32 m0, s65, 124928
    s_add_u32 s66, s66, 16384
    buffer_load_dwordx4 v50, s[24:27], s66 offen offset:0 lds
    v_mfma_f32_32x32x16_bf16 v[128:143], v[232:235], a[104:107], v[128:143]
    ds_read_b64_tr_b16 v[244:245], v63 offset:0
    ds_read_b64_tr_b16 v[246:247], v63 offset:768
    v_mfma_f32_32x32x16_bf16 v[144:159], v[232:235], a[232:235], v[144:159]
    s_waitcnt lgkmcnt(2)
    s_barrier
    ds_read_b128 v[68:71], v13 offset:0
    buffer_load_dwordx4 v51, s[24:27], s66 offen offset:1024 lds
    v_mfma_f32_32x32x16_bf16 v[128:143], v[236:239], a[108:111], v[128:143]
    ds_read_b64_tr_b16 v[224:225], v56 offset:64
    ds_read_b64_tr_b16 v[226:227], v56 offset:832
    v_mfma_f32_32x32x16_bf16 v[144:159], v[236:239], a[236:239], v[144:159]
    s_lshl_b32 s66, s23, 3
    s_add_u32 s66, s66, s85
    s_add_u32 m0, s65, 57344
    s_add_u32 s66, s66, 0
    buffer_load_dwordx4 v50, s[24:27], s66 offen offset:0 lds
    v_mfma_f32_32x32x16_bf16 v[128:143], v[240:243], a[120:123], v[128:143]
    ds_read_b64_tr_b16 v[228:229], v57 offset:64
    ds_read_b64_tr_b16 v[230:231], v57 offset:832
    v_mfma_f32_32x32x16_bf16 v[144:159], v[240:243], a[248:251], v[144:159]
    s_waitcnt lgkmcnt(2)
    v_mfma_f32_32x32x16_bf16 v[128:143], v[68:71], v[248:251], v[128:143]
    buffer_load_dwordx4 v51, s[24:27], s66 offen offset:1024 lds
    s_add_u32 m0, s65, 59392
    s_add_u32 s66, s66, 16384
    v_mfma_f32_32x32x16_bf16 v[128:143], v[244:247], a[124:127], v[128:143]
    ds_read_b64_tr_b16 v[232:233], v56 offset:24640
    ds_read_b64_tr_b16 v[234:235], v56 offset:25408
    v_mfma_f32_32x32x16_bf16 v[144:159], v[68:71], v[32:35], v[144:159]
    v_mfma_f32_32x32x16_bf16 v[144:159], v[244:247], a[252:255], v[144:159]
    buffer_load_dwordx4 v50, s[24:27], s66 offen offset:0 lds
    buffer_load_dwordx4 v51, s[24:27], s66 offen offset:1024 lds
    v_mfma_f32_16x16x32_bf16 v[72:75], v[64:67], v[224:227], v[72:75]
    v_mfma_f32_32x32x16_bf16 v[160:175], v[224:227], a[80:83], v[160:175]
    ds_read_b64_tr_b16 v[236:237], v57 offset:24640
    ds_read_b64_tr_b16 v[238:239], v57 offset:25408
    v_mfma_f32_32x32x16_bf16 v[176:191], v[224:227], a[208:211], v[176:191]
    s_waitcnt vmcnt(13)
    ds_read_b128 a[48:51], v44 offset:24576
    v_mul_f32 v128, v128, v136
    v_mul_f32 v129, v129, v137
    v_mul_f32 v130, v130, v138
    ds_read_b128 a[52:55], v45 offset:24576
    v_mul_f32 v131, v131, v139
    v_mul_f32 v132, v132, v140
    s_waitcnt lgkmcnt(4)
    v_mfma_f32_16x16x32_bf16 v[72:75], v[64:67], v[228:231], v[72:75]
    v_mul_f32 v133, v133, v141
    ds_read_b128 a[56:59], v46 offset:24576
    v_mul_f32 v134, v134, v142
    v_mfma_f32_32x32x16_bf16 v[160:175], v[228:231], a[84:87], v[160:175]
    ds_read_b64_tr_b16 v[240:241], v60 offset:64
    ds_read_b64_tr_b16 v[242:243], v60 offset:832
    v_mul_f32 v135, v135, v143
    v_mfma_f32_32x32x16_bf16 v[176:191], v[228:231], a[212:215], v[176:191]
    v_mul_f32 v128, v92, v128
    v_mul_f32 v129, v92, v129
    ds_read_b128 a[60:63], v47 offset:24576
    v_mul_f32 v130, v92, v130
    v_mul_f32 v131, v92, v131
    v_mul_f32 v132, v92, v132
    v_mul_f32 v133, v92, v133
    v_mul_f32 v134, v92, v134
    v_mul_f32 v135, v92, v135
    v_mfma_f32_16x16x32_bf16 v[72:75], v[64:67], v[232:235], v[72:75]
    v_cvt_pk_bf16_f32 v136, v128, v129
    v_cvt_pk_bf16_f32 v137, v130, v131
    v_cvt_pk_bf16_f32 v138, v132, v133
    v_cvt_pk_bf16_f32 v139, v134, v135
    v_mfma_f32_32x32x16_bf16 v[160:175], v[232:235], a[96:99], v[160:175]
    ds_read_b64_tr_b16 v[244:245], v61 offset:64
    ds_read_b64_tr_b16 v[246:247], v61 offset:832
    v_mfma_f32_32x32x16_bf16 v[176:191], v[232:235], a[224:227], v[176:191]
    s_waitcnt lgkmcnt(2)
    s_lshl_b32 s66, s32, 3
    s_add_u32 s66, s66, s85
    s_add_u32 m0, s65, 24576
    s_add_u32 s66, s66, 0
    buffer_load_dwordx4 v50, s[24:27], s66 offen offset:0 lds
    v_mfma_f32_16x16x32_bf16 v[72:75], v[64:67], v[236:239], v[72:75]
    v_mfma_f32_32x32x16_bf16 v[160:175], v[236:239], a[100:103], v[160:175]
    ds_read_b64_tr_b16 v[224:225], v58 offset:64
    ds_read_b64_tr_b16 v[226:227], v58 offset:832
    v_mfma_f32_32x32x16_bf16 v[176:191], v[236:239], a[228:231], v[176:191]
    buffer_store_dwordx4 v[136:139], v36, s[56:59], s90 offen sc1
    buffer_load_dwordx4 v51, s[24:27], s66 offen offset:1024 lds
    v_mfma_f32_16x16x32_bf16 v[72:75], v[64:67], v[240:243], v[72:75]
    v_mul_f32 v144, v144, v152
    v_mul_f32 v145, v145, v153
    v_mul_f32 v146, v146, v154
    v_mul_f32 v147, v147, v155
    v_mul_f32 v148, v148, v156
    v_mfma_f32_32x32x16_bf16 v[160:175], v[240:243], a[112:115], v[160:175]
    ds_read_b64_tr_b16 v[228:229], v59 offset:64
    ds_read_b64_tr_b16 v[230:231], v59 offset:832
    s_add_u32 m0, s65, 26624
    s_add_u32 s66, s66, 16384
    v_mfma_f32_32x32x16_bf16 v[176:191], v[240:243], a[240:243], v[176:191]
    v_mul_f32 v149, v149, v157
    buffer_load_dwordx4 v50, s[24:27], s66 offen offset:0 lds
    v_mul_f32 v150, v150, v158
    v_mul_f32 v151, v151, v159
    v_mul_f32 v144, v94, v144
    v_mul_f32 v145, v94, v145
    v_mul_f32 v146, v94, v146
    s_waitcnt lgkmcnt(2)
    v_mfma_f32_16x16x32_bf16 v[72:75], v[64:67], v[244:247], v[72:75]
    v_mul_f32 v147, v94, v147
    v_mul_f32 v148, v94, v148
    v_mul_f32 v149, v94, v149
    v_mul_f32 v150, v94, v150
    v_mul_f32 v151, v94, v151
    v_mfma_f32_32x32x16_bf16 v[160:175], v[244:247], a[116:119], v[160:175]
    ds_read_b64_tr_b16 v[232:233], v58 offset:24640
    ds_read_b64_tr_b16 v[234:235], v58 offset:25408
    v_cvt_pk_bf16_f32 v152, v144, v145
    v_mfma_f32_32x32x16_bf16 v[176:191], v[244:247], a[244:247], v[176:191]
    buffer_load_dwordx4 v51, s[24:27], s66 offen offset:1024 lds
    v_cvt_pk_bf16_f32 v153, v146, v147
    v_cvt_pk_bf16_f32 v154, v148, v149
    v_cvt_pk_bf16_f32 v155, v150, v151
    v_mfma_f32_32x32x16_bf16 v[160:175], v[224:227], a[88:91], v[160:175]
    ds_read_b64_tr_b16 v[236:237], v59 offset:24640
    ds_read_b64_tr_b16 v[238:239], v59 offset:25408
    buffer_store_dwordx4 v[152:155], v37, s[56:59], s90 offen sc1
    v_mfma_f32_32x32x16_bf16 v[176:191], v[224:227], a[216:219], v[176:191]
    s_waitcnt vmcnt(14)
    ds_read_b128 a[176:179], v44 offset:40960
    v_cvt_pk_bf16_f32 v2, v72, v72
    ds_read_b128 a[180:183], v45 offset:40960
    v_and_b32 v2, s79, v2
    v_sub_f32 v72, v72, v2
    ds_read_b128 a[184:187], v46 offset:40960
    v_cvt_pk_bf16_f32 v72, v2, v72
    s_waitcnt lgkmcnt(5)
    v_mfma_f32_32x32x16_bf16 v[160:175], v[228:231], a[92:95], v[160:175]
    ds_read_b64_tr_b16 v[240:241], v62 offset:64
    ds_read_b64_tr_b16 v[242:243], v62 offset:832
    v_mfma_f32_32x32x16_bf16 v[176:191], v[228:231], a[220:223], v[176:191]
    ds_write_b128 v254, v[72:75] offset:2048
    ds_read_b128 a[188:191], v47 offset:40960
    v_mfma_f32_32x32x16_bf16 v[160:175], v[232:235], a[104:107], v[160:175]
    ds_read_b64_tr_b16 v[244:245], v63 offset:64
    ds_read_b64_tr_b16 v[246:247], v63 offset:832
    v_mfma_f32_32x32x16_bf16 v[176:191], v[232:235], a[232:235], v[176:191]
    s_waitcnt lgkmcnt(3)
    s_barrier
    ds_read_b128 v[72:75], v13 offset:2048
    v_mfma_f32_32x32x16_bf16 v[160:175], v[236:239], a[108:111], v[160:175]
    ds_read_b64_tr_b16 v[224:225], v56 offset:128
    ds_read_b64_tr_b16 v[226:227], v56 offset:896
    v_mfma_f32_32x32x16_bf16 v[176:191], v[236:239], a[236:239], v[176:191]
    s_waitcnt lgkmcnt(5)
    s_lshl_b32 s66, s33, 3
    s_add_u32 s66, s66, s85
    s_add_u32 m0, s65, 40960
    s_add_u32 s66, s66, 0
    buffer_load_dwordx4 v50, s[24:27], s66 offen offset:0 lds
    v_mfma_f32_32x32x16_bf16 v[160:175], v[240:243], a[120:123], v[160:175]
    ds_read_b64_tr_b16 v[228:229], v57 offset:128
    ds_read_b64_tr_b16 v[230:231], v57 offset:896
    v_mfma_f32_32x32x16_bf16 v[176:191], v[240:243], a[248:251], v[176:191]
    s_waitcnt lgkmcnt(2)
    v_mfma_f32_32x32x16_bf16 v[160:175], v[72:75], v[248:251], v[160:175]
    buffer_load_dwordx4 v51, s[24:27], s66 offen offset:1024 lds
    v_mfma_f32_32x32x16_bf16 v[160:175], v[244:247], a[124:127], v[160:175]
    ds_read_b64_tr_b16 v[232:233], v56 offset:24704
    ds_read_b64_tr_b16 v[234:235], v56 offset:25472
    v_mfma_f32_32x32x16_bf16 v[176:191], v[72:75], v[32:35], v[176:191]
    v_mfma_f32_32x32x16_bf16 v[176:191], v[244:247], a[252:255], v[176:191]
    s_add_u32 m0, s65, 43008
    s_add_u32 s66, s66, 16384
    buffer_load_dwordx4 v50, s[24:27], s66 offen offset:0 lds
    buffer_load_dwordx4 v51, s[24:27], s66 offen offset:1024 lds
    v_mfma_f32_16x16x32_bf16 v[76:79], v[64:67], v[224:227], v[76:79]
    buffer_load_dword v9, v8, s[56:59], 0 offen sc1
    v_mfma_f32_32x32x16_bf16 v[192:207], v[224:227], a[80:83], v[192:207]
    ds_read_b64_tr_b16 v[236:237], v57 offset:24704
    ds_read_b64_tr_b16 v[238:239], v57 offset:25472
    v_mfma_f32_32x32x16_bf16 v[208:223], v[224:227], a[208:211], v[208:223]
    v_mul_f32 v160, v160, v168
    v_mul_f32 v161, v161, v169
    v_mul_f32 v162, v162, v170
    v_mul_f32 v163, v163, v171
    v_mul_f32 v164, v164, v172
    v_mul_f32 v165, v165, v173
    s_waitcnt lgkmcnt(2)
    v_mfma_f32_16x16x32_bf16 v[76:79], v[64:67], v[228:231], v[76:79]
    v_mul_f32 v166, v166, v174
    v_mul_f32 v167, v167, v175
    v_mul_f32 v160, v92, v160
    v_mfma_f32_32x32x16_bf16 v[192:207], v[228:231], a[84:87], v[192:207]
    ds_read_b64_tr_b16 v[240:241], v60 offset:128
    ds_read_b64_tr_b16 v[242:243], v60 offset:896
    v_mul_f32 v161, v92, v161
    v_mfma_f32_32x32x16_bf16 v[208:223], v[228:231], a[212:215], v[208:223]
    v_mul_f32 v162, v92, v162
    v_mul_f32 v163, v92, v163
    v_mul_f32 v164, v92, v164
    v_mul_f32 v165, v92, v165
    v_mul_f32 v166, v92, v166
    v_mul_f32 v167, v92, v167
    v_mfma_f32_16x16x32_bf16 v[76:79], v[64:67], v[232:235], v[76:79]
    v_cvt_pk_bf16_f32 v168, v160, v161
    v_cvt_pk_bf16_f32 v169, v162, v163
    v_mfma_f32_32x32x16_bf16 v[192:207], v[232:235], a[96:99], v[192:207]
    ds_read_b64_tr_b16 v[244:245], v61 offset:128
    ds_read_b64_tr_b16 v[246:247], v61 offset:896
    v_cvt_pk_bf16_f32 v170, v164, v165
    v_mfma_f32_32x32x16_bf16 v[208:223], v[232:235], a[224:227], v[208:223]
    v_cvt_pk_bf16_f32 v171, v166, v167
    buffer_store_dwordx4 v[168:171], v36, s[56:59], s91 offen sc1
    s_waitcnt lgkmcnt(2)
    v_mfma_f32_16x16x32_bf16 v[76:79], v[64:67], v[236:239], v[76:79]
    v_mul_f32 v176, v176, v184
    v_mul_f32 v177, v177, v185
    v_mul_f32 v178, v178, v186
    v_mfma_f32_32x32x16_bf16 v[192:207], v[236:239], a[100:103], v[192:207]
    ds_read_b64_tr_b16 v[224:225], v58 offset:128
    ds_read_b64_tr_b16 v[226:227], v58 offset:896
    v_mul_f32 v179, v179, v187
    v_mfma_f32_32x32x16_bf16 v[208:223], v[236:239], a[228:231], v[208:223]
    v_mul_f32 v180, v180, v188
    v_mul_f32 v181, v181, v189
    v_mul_f32 v182, v182, v190
    v_mul_f32 v183, v183, v191
    v_mul_f32 v176, v94, v176
    v_mul_f32 v177, v94, v177
    v_mfma_f32_16x16x32_bf16 v[76:79], v[64:67], v[240:243], v[76:79]
    s_waitcnt vmcnt(6)
    buffer_store_dword v41, v40, s[56:59], 0 offen offset:128 sc1
    v_mul_f32 v178, v94, v178
    v_mul_f32 v179, v94, v179
    v_mul_f32 v180, v94, v180
    v_mfma_f32_32x32x16_bf16 v[192:207], v[240:243], a[112:115], v[192:207]
    ds_read_b64_tr_b16 v[228:229], v59 offset:128
    ds_read_b64_tr_b16 v[230:231], v59 offset:896
    v_mfma_f32_32x32x16_bf16 v[208:223], v[240:243], a[240:243], v[208:223]
    v_mul_f32 v181, v94, v181
    v_mul_f32 v182, v94, v182
    v_mul_f32 v183, v94, v183
    v_cvt_pk_bf16_f32 v184, v176, v177
    v_cvt_pk_bf16_f32 v185, v178, v179
    v_cvt_pk_bf16_f32 v186, v180, v181
    s_waitcnt lgkmcnt(2)
    v_mfma_f32_16x16x32_bf16 v[76:79], v[64:67], v[244:247], v[76:79]
    v_cvt_pk_bf16_f32 v187, v182, v183
    v_mfma_f32_32x32x16_bf16 v[192:207], v[244:247], a[116:119], v[192:207]
    ds_read_b64_tr_b16 v[232:233], v58 offset:24704
    ds_read_b64_tr_b16 v[234:235], v58 offset:25472
    v_mfma_f32_32x32x16_bf16 v[208:223], v[244:247], a[244:247], v[208:223]
    buffer_store_dwordx4 v[184:187], v37, s[56:59], s91 offen sc1
    v_mfma_f32_32x32x16_bf16 v[192:207], v[224:227], a[88:91], v[192:207]
    ds_read_b64_tr_b16 v[236:237], v59 offset:24704
    ds_read_b64_tr_b16 v[238:239], v59 offset:25472
parallel_sum__ssm_conv_s5__glu_gated_bilinear__prompt_kernel_chkS:
    s_waitcnt vmcnt(3)
    v_cmp_ne_u32 s[100:101], s71, v9
    s_nop 1
    s_and_b32 s100, s100, s72
    s_cbranch_scc1 parallel_sum__ssm_conv_s5__glu_gated_bilinear__prompt_kernel_slowS
parallel_sum__ssm_conv_s5__glu_gated_bilinear__prompt_kernel_goS:
    v_mfma_f32_32x32x16_bf16 v[208:223], v[224:227], a[216:219], v[208:223]
    s_xor_b32 s88, s86, 0
    buffer_load_dwordx4 a[64:67], v17, s[8:11], s88 offen offset:0 sc1
    v_cvt_pk_bf16_f32 v2, v76, v76
    v_and_b32 v2, s79, v2
    v_sub_f32 v76, v76, v2
    v_cvt_pk_bf16_f32 v76, v2, v76
    s_waitcnt lgkmcnt(2)
    v_mfma_f32_32x32x16_bf16 v[192:207], v[228:231], a[92:95], v[192:207]
    ds_read_b64_tr_b16 v[240:241], v62 offset:128
    ds_read_b64_tr_b16 v[242:243], v62 offset:896
    buffer_load_dwordx4 a[192:195], v17, s[8:11], s88 offen offset:1024 sc1
    v_mfma_f32_32x32x16_bf16 v[208:223], v[228:231], a[220:223], v[208:223]
    s_xor_b32 s88, s86, 2048
    buffer_load_dwordx4 a[68:71], v17, s[8:11], s88 offen offset:0 sc1
    ds_write_b128 v254, v[76:79] offset:4096
    v_mfma_f32_32x32x16_bf16 v[192:207], v[232:235], a[104:107], v[192:207]
    ds_read_b64_tr_b16 v[244:245], v63 offset:128
    ds_read_b64_tr_b16 v[246:247], v63 offset:896
    v_mfma_f32_32x32x16_bf16 v[208:223], v[232:235], a[232:235], v[208:223]
    buffer_load_dwordx4 a[196:199], v17, s[8:11], s88 offen offset:1024 sc1
    s_waitcnt lgkmcnt(3)
    v_mfma_f32_32x32x16_bf16 v[192:207], v[236:239], a[108:111], v[192:207]
    s_waitcnt lgkmcnt(2)
    s_barrier
    ds_read_b128 v[76:79], v13 offset:4096
    s_xor_b32 s88, s86, 4096
    buffer_load_dwordx4 a[72:75], v17, s[8:11], s88 offen offset:0 sc1
    v_mfma_f32_32x32x16_bf16 v[208:223], v[236:239], a[236:239], v[208:223]
    buffer_load_dwordx4 a[200:203], v17, s[8:11], s88 offen offset:1024 sc1
    v_mfma_f32_32x32x16_bf16 v[192:207], v[240:243], a[120:123], v[192:207]
    v_mfma_f32_32x32x16_bf16 v[208:223], v[240:243], a[248:251], v[208:223]
    s_xor_b32 s88, s86, 6144
    buffer_load_dwordx4 a[76:79], v17, s[8:11], s88 offen offset:0 sc1
    s_waitcnt lgkmcnt(0)
    v_mfma_f32_32x32x16_bf16 v[192:207], v[244:247], a[124:127], v[192:207]
    v_mfma_f32_32x32x16_bf16 v[192:207], v[76:79], v[248:251], v[192:207]
    v_mfma_f32_32x32x16_bf16 v[208:223], v[76:79], v[32:35], v[208:223]
    buffer_load_dwordx4 a[204:207], v17, s[8:11], s88 offen offset:1024 sc1
    v_mfma_f32_32x32x16_bf16 v[208:223], v[244:247], a[252:255], v[208:223]
    s_xor_b32 s88, s86, 8192
    buffer_load_dwordx4 a[80:83], v17, s[8:11], s88 offen offset:0 sc1
    buffer_load_dwordx4 a[208:211], v17, s[8:11], s88 offen offset:1024 sc1
    s_barrier
    s_nop 4
    v_pk_mul_f32 v[192:193], v[192:193], v[200:201]
    v_pk_mul_f32 v[194:195], v[194:195], v[202:203]
    v_pk_mul_f32 v[196:197], v[196:197], v[204:205]
    v_pk_mul_f32 v[198:199], v[198:199], v[206:207]
    v_pk_mul_f32 v[192:193], v[192:193], v[92:93] op_sel_hi:[1,0]
    v_pk_mul_f32 v[194:195], v[194:195], v[92:93] op_sel_hi:[1,0]
    v_pk_mul_f32 v[196:197], v[196:197], v[92:93] op_sel_hi:[1,0]
    v_pk_mul_f32 v[198:199], v[198:199], v[92:93] op_sel_hi:[1,0]
    v_cvt_pk_bf16_f32 v200, v192, v193
    v_cvt_pk_bf16_f32 v201, v194, v195
    v_cvt_pk_bf16_f32 v202, v196, v197
    v_cvt_pk_bf16_f32 v203, v198, v199
    buffer_store_dwordx4 v[200:203], v11, s[56:59], s90 offen sc1
    v_pk_mul_f32 v[208:209], v[208:209], v[216:217]
    v_pk_mul_f32 v[210:211], v[210:211], v[218:219]
    v_pk_mul_f32 v[212:213], v[212:213], v[220:221]
    v_pk_mul_f32 v[214:215], v[214:215], v[222:223]
    v_pk_mul_f32 v[208:209], v[208:209], v[94:95] op_sel_hi:[1,0]
    v_pk_mul_f32 v[210:211], v[210:211], v[94:95] op_sel_hi:[1,0]
    v_pk_mul_f32 v[212:213], v[212:213], v[94:95] op_sel_hi:[1,0]
    v_pk_mul_f32 v[214:215], v[214:215], v[94:95] op_sel_hi:[1,0]
    v_cvt_pk_bf16_f32 v216, v208, v209
    v_cvt_pk_bf16_f32 v217, v210, v211
    v_cvt_pk_bf16_f32 v218, v212, v213
    v_cvt_pk_bf16_f32 v219, v214, v215
    buffer_store_dwordx4 v[216:219], v12, s[56:59], s90 offen sc1
    s_xor_b32 s88, s86, 10240
    buffer_load_dwordx4 a[84:87], v17, s[8:11], s88 offen offset:0 sc1
    buffer_load_dwordx4 a[212:215], v17, s[8:11], s88 offen offset:1024 sc1
    s_xor_b32 s88, s86, 12288
    buffer_load_dwordx4 a[96:99], v17, s[8:11], s88 offen offset:0 sc1
    buffer_load_dwordx4 a[224:227], v17, s[8:11], s88 offen offset:1024 sc1
    s_xor_b32 s88, s86, 14336
    buffer_load_dwordx4 a[100:103], v17, s[8:11], s88 offen offset:0 sc1
    buffer_load_dwordx4 a[228:231], v17, s[8:11], s88 offen offset:1024 sc1
    s_waitcnt vmcnt(17)
    v_mfma_f32_32x32x16_bf16 v[96:111], a[0:3], a[64:67], 0
    s_xor_b32 s88, s86, 16384
    buffer_load_dwordx4 a[112:115], v17, s[8:11], s88 offen offset:0 sc1
    v_lshrrev_b32 v3, 5, v1
    v_bfe_u32 v5, v1, 2, 2
    v_mfma_f32_32x32x16_bf16 v[128:143], a[128:131], a[64:67], 0
    buffer_load_dwordx4 a[240:243], v17, s[8:11], s88 offen offset:1024 sc1
    v_lshl_add_u32 v6, v3, 2, v5
    v_lshlrev_b32 v6, 7, v6
    v_bfe_u32 v7, v1, 4, 1
    s_waitcnt vmcnt(18)
    v_mfma_f32_32x32x16_bf16 v[112:127], a[0:3], a[192:195], 0
    s_xor_b32 s88, s86, 18432
    buffer_load_dwordx4 a[116:119], v17, s[8:11], s88 offen offset:0 sc1
    v_lshl_add_u32 v6, v7, 5, v6
    v_bfe_u32 v7, v1, 1, 1
    v_mfma_f32_32x32x16_bf16 v[144:159], a[128:131], a[192:195], 0
    buffer_load_dwordx4 a[244:247], v17, s[8:11], s88 offen offset:1024 sc1
    v_lshl_add_u32 v6, v7, 4, v6
    v_and_b32 v7, 1, v1
    s_waitcnt vmcnt(19)
    v_mfma_f32_32x32x16_bf16 v[96:111], a[4:7], a[68:71], v[96:111]
    s_xor_b32 s88, s86, 20480
    buffer_load_dwordx4 a[88:91], v17, s[8:11], s88 offen offset:0 sc1
    v_lshl_add_u32 v6, v7, 3, v6
    v_bfe_u32 v7, v1, 3, 1
    v_mfma_f32_32x32x16_bf16 v[128:143], a[132:135], a[68:71], v[128:143]
    buffer_load_dwordx4 a[216:219], v17, s[8:11], s88 offen offset:1024 sc1
    v_lshl_add_u32 v6, v7, 6, v6
    v_add_u32 v80, s65, v6
    v_xor_b32 v81, 64, v80
    s_waitcnt vmcnt(20)
    v_mfma_f32_32x32x16_bf16 v[112:127], a[4:7], a[196:199], v[112:127]
    s_xor_b32 s88, s86, 22528
    buffer_load_dwordx4 a[92:95], v17, s[8:11], s88 offen offset:0 sc1
    v_add_u32 v82, 0x10000, v80
    v_add_u32 v83, 0x10000, v81
    v_mfma_f32_32x32x16_bf16 v[144:159], a[132:135], a[196:199], v[144:159]
    buffer_store_dword v41, v40, s[56:59], 0 offen offset:256 sc1
    v_add_u32 v84, 0x20000, v80
    v_add_u32 v85, 0x20000, v81
    s_waitcnt vmcnt(21)
    v_mfma_f32_32x32x16_bf16 v[96:111], a[8:11], a[72:75], v[96:111]
    buffer_load_dwordx4 a[220:223], v17, s[8:11], s88 offen offset:1024 sc1
    v_lshrrev_b32 v4, 5, v1
    v_bfe_u32 v5, v1, 4, 1
    v_lshl_add_u32 v4, v5, 3, v4
    s_lshl_b32 s19, s60, 1
    v_mfma_f32_32x32x16_bf16 v[128:143], a[136:139], a[72:75], v[128:143]
    s_xor_b32 s88, s86, 24576
    buffer_load_dwordx4 a[104:107], v17, s[8:11], s88 offen offset:0 sc1
    v_add_u32 v4, s19, v4
    v_and_b32 v5, 15, v1
    s_lshl_b32 s19, s80, 6
    v_add_u32 v6, s19, v4
    s_lshl_b32 s19, s81, 6
    s_waitcnt vmcnt(22)
    v_mfma_f32_32x32x16_bf16 v[112:127], a[8:11], a[200:203], v[112:127]
    buffer_load_dwordx4 a[232:235], v17, s[8:11], s88 offen offset:1024 sc1
    v_lshl_add_u32 v7, v5, 2, s19
    v_lshl_add_u32 v3, v6, 9, v7
    v_lshlrev_b32 v18, 1, v3
    v_lshlrev_b32 v19, 2, v3
    v_mfma_f32_32x32x16_bf16 v[144:159], a[136:139], a[200:203], v[144:159]
    s_xor_b32 s88, s86, 26624
    buffer_load_dwordx4 a[108:111], v17, s[8:11], s88 offen offset:0 sc1
    v_and_b32 v5, 3, v1
    v_lshl_add_u32 v6, v5, 4, v6
    v_lshlrev_b32 v20, 4, v6
    v_lshlrev_b32 v21, 1, v7
    s_waitcnt vmcnt(23)
    v_mfma_f32_32x32x16_bf16 v[96:111], a[12:15], a[76:79], v[96:111]
    buffer_load_dwordx4 a[236:239], v17, s[8:11], s88 offen offset:1024 sc1
    v_add_u32 v20, 0xa00000, v20
    buffer_load_dwordx2 v[24:25], v18, s[36:39], 0 offen
    v_mfma_f32_32x32x16_bf16 v[128:143], a[140:143], a[76:79], v[128:143]
    s_xor_b32 s88, s86, 28672
    buffer_load_dwordx4 a[120:123], v17, s[8:11], s88 offen offset:0 sc1
    s_waitcnt vmcnt(25)
    v_mfma_f32_32x32x16_bf16 v[112:127], a[12:15], a[204:207], v[112:127]
    buffer_load_dwordx4 a[248:251], v17, s[8:11], s88 offen offset:1024 sc1
    s_mov_b32 s19, 16384
    buffer_load_dwordx2 v[26:27], v18, s[36:39], s19 offen
    v_mfma_f32_32x32x16_bf16 v[144:159], a[140:143], a[204:207], v[144:159]
    s_xor_b32 s88, s86, 30720
    buffer_load_dwordx4 a[124:127], v17, s[8:11], s88 offen offset:0 sc1
    s_mov_b32 s19, 32768
    buffer_load_dwordx2 v[28:29], v18, s[36:39], s19 offen
    s_waitcnt vmcnt(28)
    v_mfma_f32_32x32x16_bf16 v[96:111], a[16:19], a[80:83], v[96:111]
    buffer_load_dword v10, v8, s[56:59], 0 offen offset:128 sc1
    s_mov_b32 s19, 49152
    buffer_load_dwordx2 v[30:31], v18, s[36:39], s19 offen
    v_mfma_f32_32x32x16_bf16 v[128:143], a[144:147], a[80:83], v[128:143]
    buffer_load_dwordx4 a[252:255], v17, s[8:11], s88 offen offset:1024 sc1
    s_waitcnt vmcnt(30)
    v_mfma_f32_32x32x16_bf16 v[112:127], a[16:19], a[208:211], v[112:127]
    s_lshl_b32 s66, s22, 3
    s_add_u32 s66, s66, s85
    s_add_u32 m0, s65, 73728
    s_add_u32 s66, s66, 32768
    buffer_load_dwordx4 v50, s[24:27], s66 offen offset:0 lds
    global_load_dwordx2 v[42:43], v21, s[20:21]
    v_mfma_f32_32x32x16_bf16 v[144:159], a[144:147], a[208:211], v[144:159]
    buffer_load_dwordx4 v51, s[24:27], s66 offen offset:1024 lds
    buffer_load_dwordx4 v[86:89], v20, s[56:59], 0 offen sc1
    s_waitcnt vmcnt(31)
    v_mfma_f32_32x32x16_bf16 v[96:111], a[20:23], a[84:87], v[96:111]
    s_add_u32 m0, s65, 75776
    s_add_u32 s66, s66, 16384
    buffer_load_dwordx4 v50, s[24:27], s66 offen offset:0 lds
    v_mfma_f32_32x32x16_bf16 v[128:143], a[148:151], a[84:87], v[128:143]
    buffer_store_dword v41, v40, s[56:59], 0 offen offset:384 sc1
    s_waitcnt vmcnt(32)
    v_mfma_f32_32x32x16_bf16 v[112:127], a[20:23], a[212:215], v[112:127]
    buffer_load_dwordx4 v51, s[24:27], s66 offen offset:1024 lds
    v_mfma_f32_32x32x16_bf16 v[144:159], a[148:151], a[212:215], v[144:159]
    s_waitcnt vmcnt(32)
    v_mfma_f32_32x32x16_bf16 v[96:111], a[24:27], a[96:99], v[96:111]
    s_lshl_b32 s66, s23, 3
    s_add_u32 s66, s66, s85
    s_add_u32 m0, s65, 90112
    s_add_u32 s66, s66, 32768
    buffer_load_dwordx4 v50, s[24:27], s66 offen offset:0 lds
    v_mfma_f32_32x32x16_bf16 v[128:143], a[152:155], a[96:99], v[128:143]
    buffer_load_dwordx4 v51, s[24:27], s66 offen offset:1024 lds
    s_waitcnt vmcnt(33)
    v_mfma_f32_32x32x16_bf16 v[112:127], a[24:27], a[224:227], v[112:127]
    v_mfma_f32_32x32x16_bf16 v[144:159], a[152:155], a[224:227], v[144:159]
    s_waitcnt vmcnt(32)
    v_mfma_f32_32x32x16_bf16 v[96:111], a[28:31], a[100:103], v[96:111]
    s_add_u32 m0, s65, 92160
    s_add_u32 s66, s66, 16384
    buffer_load_dwordx4 v50, s[24:27], s66 offen offset:0 lds
    v_mfma_f32_32x32x16_bf16 v[128:143], a[156:159], a[100:103], v[128:143]
    buffer_load_dwordx4 v51, s[24:27], s66 offen offset:1024 lds
    s_waitcnt vmcnt(33)
    v_mfma_f32_32x32x16_bf16 v[112:127], a[28:31], a[228:231], v[112:127]
parallel_sum__ssm_conv_s5__glu_gated_bilinear__prompt_kernel_chkG0:
    s_waitcnt vmcnt(13)
    v_cmp_ne_u32 s[100:101], s71, v10
    s_nop 1
    s_and_b32 s100, s100, s73
    s_cbranch_scc1 parallel_sum__ssm_conv_s5__glu_gated_bilinear__prompt_kernel_slowG0
parallel_sum__ssm_conv_s5__glu_gated_bilinear__prompt_kernel_goG0:
    v_mfma_f32_32x32x16_bf16 v[144:159], a[156:159], a[228:231], v[144:159]
    v_mfma_f32_32x32x16_bf16 v[96:111], a[32:35], a[112:115], v[96:111]
    s_add_u32 s88, s22, 0
    buffer_load_dwordx4 a[0:3], v17, s[8:11], s88 offen offset:0 sc1
    v_mfma_f32_32x32x16_bf16 v[128:143], a[160:163], a[112:115], v[128:143]
    buffer_load_dwordx4 a[128:131], v17, s[8:11], s88 offen offset:1024 sc1
    v_mfma_f32_32x32x16_bf16 v[112:127], a[32:35], a[240:243], v[112:127]
    v_mfma_f32_32x32x16_bf16 v[144:159], a[160:163], a[240:243], v[144:159]
    v_mfma_f32_32x32x16_bf16 v[96:111], a[36:39], a[116:119], v[96:111]
    buffer_load_dwordx4 a[64:67], v17, s[8:11], s88 offen offset:2048 sc1
    v_mfma_f32_32x32x16_bf16 v[128:143], a[164:167], a[116:119], v[128:143]
    buffer_load_dwordx4 a[192:195], v17, s[8:11], s88 offen offset:3072 sc1
    v_mfma_f32_32x32x16_bf16 v[112:127], a[36:39], a[244:247], v[112:127]
    v_mfma_f32_32x32x16_bf16 v[144:159], a[164:167], a[244:247], v[144:159]
    v_mfma_f32_32x32x16_bf16 v[96:111], a[40:43], a[88:91], v[96:111]
    s_add_u32 s88, s23, 0
    buffer_load_dwordx4 a[4:7], v17, s[8:11], s88 offen offset:0 sc1
    s_waitcnt vmcnt(14)
    v_lshlrev_b32 v176, 16, v42
    v_and_b32 v177, s79, v42
    v_lshlrev_b32 v178, 16, v43
    v_and_b32 v179, s79, v43
    v_mfma_f32_32x32x16_bf16 v[128:143], a[168:171], a[88:91], v[128:143]
    buffer_load_dwordx4 a[132:135], v17, s[8:11], s88 offen offset:1024 sc1
    s_waitcnt vmcnt(13)
    v_mov_b32_dpp v90, v86 quad_perm:[0,0,0,0] row_mask:0xf bank_mask:0xf
    v_mov_b32_dpp v91, v88 quad_perm:[0,0,0,0] row_mask:0xf bank_mask:0xf
    v_lshlrev_b32 v180, 16, v24
    v_mfma_f32_32x32x16_bf16 v[112:127], a[40:43], a[216:219], v[112:127]
    v_and_b32 v181, s79, v24
    v_lshlrev_b32 v182, 16, v25
    v_and_b32 v183, s79, v25
    v_sub_f32 v160, v180, v90
    v_mfma_f32_32x32x16_bf16 v[144:159], a[168:171], a[216:219], v[144:159]
    v_sub_f32 v161, v181, v90
    v_sub_f32 v162, v182, v90
    v_sub_f32 v163, v183, v90
    v_cvt_pk_bf16_f32 v184, v160, v161
    v_mfma_f32_32x32x16_bf16 v[96:111], a[44:47], a[92:95], v[96:111]
    buffer_load_dwordx4 a[68:71], v17, s[8:11], s88 offen offset:2048 sc1
    v_cvt_pk_bf16_f32 v185, v162, v163
    v_lshlrev_b32 v160, 16, v184
    v_and_b32 v161, s79, v184
    v_mfma_f32_32x32x16_bf16 v[128:143], a[172:175], a[92:95], v[128:143]
    buffer_load_dwordx4 a[196:199], v17, s[8:11], s88 offen offset:3072 sc1
    v_lshlrev_b32 v162, 16, v185
    v_and_b32 v163, s79, v185
    v_mul_f32 v160, v160, v91
    v_mul_f32 v161, v161, v91
    v_mfma_f32_32x32x16_bf16 v[112:127], a[44:47], a[220:223], v[112:127]
    v_mul_f32 v162, v162, v91
    v_mul_f32 v163, v163, v91
    v_cvt_pk_bf16_f32 v184, v160, v161
    v_cvt_pk_bf16_f32 v185, v162, v163
    v_mfma_f32_32x32x16_bf16 v[144:159], a[172:175], a[220:223], v[144:159]
    v_lshlrev_b32 v160, 16, v184
    v_and_b32 v161, s79, v184
    v_lshlrev_b32 v162, 16, v185
    v_mfma_f32_32x32x16_bf16 v[96:111], a[48:51], a[104:107], v[96:111]
    buffer_load_dword v10, v8, s[56:59], 0 offen offset:256 sc1
    v_and_b32 v163, s79, v185
    v_mul_f32 v160, v160, v176
    v_mul_f32 v161, v161, v177
    v_mul_f32 v162, v162, v178
    v_mfma_f32_32x32x16_bf16 v[128:143], a[176:179], a[104:107], v[128:143]
    s_add_u32 s88, s32, 0
    buffer_load_dwordx4 a[8:11], v17, s[8:11], s88 offen offset:0 sc1
    v_mul_f32 v163, v163, v179
    v_cvt_pk_bf16_f32 v184, v160, v161
    v_cvt_pk_bf16_f32 v185, v162, v163
    v_lshlrev_b32 v160, 16, v184
    v_mfma_f32_32x32x16_bf16 v[112:127], a[48:51], a[232:235], v[112:127]
    buffer_load_dwordx4 a[136:139], v17, s[8:11], s88 offen offset:1024 sc1
    v_and_b32 v161, s79, v184
    v_lshlrev_b32 v162, 16, v185
    v_and_b32 v163, s79, v185
    v_add_f32 v160, v160, v180
    v_mfma_f32_32x32x16_bf16 v[144:159], a[176:179], a[232:235], v[144:159]
    v_add_f32 v161, v161, v181
    v_add_f32 v162, v162, v182
    v_add_f32 v163, v163, v183
    v_mfma_f32_32x32x16_bf16 v[96:111], a[52:55], a[108:111], v[96:111]
    buffer_load_dwordx4 a[72:75], v17, s[8:11], s88 offen offset:2048 sc1
    v_mov_b32_dpp v90, v86 quad_perm:[1,1,1,1] row_mask:0xf bank_mask:0xf
    v_mov_b32_dpp v91, v88 quad_perm:[1,1,1,1] row_mask:0xf bank_mask:0xf
    v_lshlrev_b32 v180, 16, v26
    v_and_b32 v181, s79, v26
    v_mfma_f32_32x32x16_bf16 v[128:143], a[180:183], a[108:111], v[128:143]
    buffer_load_dwordx4 a[200:203], v17, s[8:11], s88 offen offset:3072 sc1
    v_lshlrev_b32 v182, 16, v27
    v_and_b32 v183, s79, v27
    v_sub_f32 v164, v180, v90
    v_sub_f32 v165, v181, v90
    v_mfma_f32_32x32x16_bf16 v[112:127], a[52:55], a[236:239], v[112:127]
    v_sub_f32 v166, v182, v90
    v_sub_f32 v167, v183, v90
    v_cvt_pk_bf16_f32 v184, v164, v165
    v_mfma_f32_32x32x16_bf16 v[144:159], a[180:183], a[236:239], v[144:159]
    v_cvt_pk_bf16_f32 v185, v166, v167
    v_lshlrev_b32 v164, 16, v184
    v_and_b32 v165, s79, v184
    v_lshlrev_b32 v166, 16, v185
    v_mfma_f32_32x32x16_bf16 v[96:111], a[56:59], a[120:123], v[96:111]
    ds_read_b64_tr_b16 v[192:193], v82 offset:57344
    s_add_u32 s88, s33, 0
    buffer_load_dwordx4 a[12:15], v17, s[8:11], s88 offen offset:0 sc1
    v_and_b32 v167, s79, v185
    v_mfma_f32_32x32x16_bf16 v[128:143], a[184:187], a[120:123], v[128:143]
    ds_read_b64_tr_b16 v[194:195], v82 offset:58368
    buffer_load_dwordx4 a[140:143], v17, s[8:11], s88 offen offset:1024 sc1
    v_mul_f32 v164, v164, v91
    v_mul_f32 v165, v165, v91
    v_mfma_f32_32x32x16_bf16 v[112:127], a[56:59], a[248:251], v[112:127]
    ds_read_b64_tr_b16 v[196:197], v83 offset:57344
    v_mul_f32 v166, v166, v91
    v_mul_f32 v167, v167, v91
    v_mfma_f32_32x32x16_bf16 v[144:159], a[184:187], a[248:251], v[144:159]
    ds_read_b64_tr_b16 v[198:199], v83 offset:58368
    v_cvt_pk_bf16_f32 v184, v164, v165
    v_cvt_pk_bf16_f32 v185, v166, v167
    v_mfma_f32_32x32x16_bf16 v[96:111], a[60:63], a[124:127], v[96:111]
    ds_read_b64_tr_b16 v[200:201], v82 offset:59392
    buffer_load_dwordx4 a[76:79], v17, s[8:11], s88 offen offset:2048 sc1
    v_lshlrev_b32 v164, 16, v184
    v_mfma_f32_32x32x16_bf16 v[128:143], a[188:191], a[124:127], v[128:143]
    ds_read_b64_tr_b16 v[202:203], v82 offset:60416
    buffer_load_dwordx4 a[204:207], v17, s[8:11], s88 offen offset:3072 sc1
    v_and_b32 v165, s79, v184
    v_lshlrev_b32 v166, 16, v185
    v_mfma_f32_32x32x16_bf16 v[112:127], a[60:63], a[252:255], v[112:127]
    ds_read_b64_tr_b16 v[204:205], v83 offset:59392
    v_and_b32 v167, s79, v185
    v_mul_f32 v164, v164, v176
    v_mfma_f32_32x32x16_bf16 v[144:159], a[188:191], a[252:255], v[144:159]
    ds_read_b64_tr_b16 v[206:207], v83 offset:60416
    v_mul_f32 v165, v165, v177
    v_mul_f32 v166, v166, v178
    s_waitcnt vmcnt(16) lgkmcnt(3)
    v_mfma_f32_32x32x16_bf16 v[96:111], v[192:195], a[0:3], v[96:111]
    ds_read_b64_tr_b16 v[208:209], v80 offset:57344
parallel_sum__ssm_conv_s5__glu_gated_bilinear__prompt_kernel_chkG1:
    s_waitcnt vmcnt(8)
    v_cmp_ne_u32 s[100:101], s71, v10
    s_nop 1
    s_and_b32 s100, s100, s73
    s_cbranch_scc1 parallel_sum__ssm_conv_s5__glu_gated_bilinear__prompt_kernel_slowG1
parallel_sum__ssm_conv_s5__glu_gated_bilinear__prompt_kernel_goG1:
    v_mul_f32 v167, v167, v179
    v_mfma_f32_32x32x16_bf16 v[128:143], v[196:199], a[0:3], v[128:143]
    ds_read_b64_tr_b16 v[210:211], v80 offset:58368
    s_add_u32 s88, s22, 4096
    buffer_load_dwordx4 a[16:19], v17, s[8:11], s88 offen offset:0 sc1
    v_cvt_pk_bf16_f32 v184, v164, v165
    v_cvt_pk_bf16_f32 v185, v166, v167
    v_mfma_f32_32x32x16_bf16 v[112:127], v[192:195], a[128:131], v[112:127]
    ds_read_b64_tr_b16 v[212:213], v81 offset:57344
    buffer_load_dwordx4 a[144:147], v17, s[8:11], s88 offen offset:1024 sc1
    v_lshlrev_b32 v164, 16, v184
    v_and_b32 v165, s79, v184
    v_mfma_f32_32x32x16_bf16 v[144:159], v[196:199], a[128:131], v[144:159]
    ds_read_b64_tr_b16 v[214:215], v81 offset:58368
    v_lshlrev_b32 v166, 16, v185
    v_and_b32 v167, s79, v185
    s_waitcnt lgkmcnt(3)
    v_mfma_f32_32x32x16_bf16 v[96:111], v[200:203], a[64:67], v[96:111]
    ds_read_b64_tr_b16 v[216:217], v80 offset:59392
    buffer_load_dwordx4 a[80:83], v17, s[8:11], s88 offen offset:2048 sc1
    v_add_f32 v164, v164, v180
    v_add_f32 v165, v165, v181
    v_mfma_f32_32x32x16_bf16 v[128:143], v[204:207], a[64:67], v[128:143]
    ds_read_b64_tr_b16 v[218:219], v80 offset:60416
    buffer_load_dwordx4 a[208:211], v17, s[8:11], s88 offen offset:3072 sc1
    v_add_f32 v166, v166, v182
    v_add_f32 v167, v167, v183
    v_mfma_f32_32x32x16_bf16 v[112:127], v[200:203], a[192:195], v[112:127]
    ds_read_b64_tr_b16 v[220:221], v81 offset:59392
    v_mov_b32_dpp v90, v86 quad_perm:[2,2,2,2] row_mask:0xf bank_mask:0xf
    v_mfma_f32_32x32x16_bf16 v[144:159], v[204:207], a[192:195], v[144:159]
    ds_read_b64_tr_b16 v[222:223], v81 offset:60416
    v_mov_b32_dpp v91, v88 quad_perm:[2,2,2,2] row_mask:0xf bank_mask:0xf
    v_lshlrev_b32 v180, 16, v28
    s_waitcnt lgkmcnt(3)
    v_mfma_f32_32x32x16_bf16 v[96:111], v[208:211], a[4:7], v[96:111]
    ds_read_b64_tr_b16 v[192:193], v80 offset:24576
    s_lshl_b32 s66, s32, 3
    s_add_u32 s66, s66, s85
    s_add_u32 m0, s65, 106496
    s_add_u32 s66, s66, 32768
    buffer_load_dwordx4 v50, s[24:27], s66 offen offset:0 lds
    v_and_b32 v181, s79, v28
    v_mfma_f32_32x32x16_bf16 v[128:143], v[212:215], a[4:7], v[128:143]
    ds_read_b64_tr_b16 v[194:195], v80 offset:25600
    buffer_load_dwordx4 v51, s[24:27], s66 offen offset:1024 lds
    v_lshlrev_b32 v182, 16, v29
    v_and_b32 v183, s79, v29
    v_mfma_f32_32x32x16_bf16 v[112:127], v[208:211], a[132:135], v[112:127]
    ds_read_b64_tr_b16 v[196:197], v81 offset:24576
    v_sub_f32 v168, v180, v90
    v_sub_f32 v169, v181, v90
    v_mfma_f32_32x32x16_bf16 v[144:159], v[212:215], a[132:135], v[144:159]
    ds_read_b64_tr_b16 v[198:199], v81 offset:25600
    v_sub_f32 v170, v182, v90
    v_sub_f32 v171, v183, v90
    s_waitcnt lgkmcnt(3)
    v_mfma_f32_32x32x16_bf16 v[96:111], v[216:219], a[68:71], v[96:111]
    ds_read_b64_tr_b16 v[200:201], v80 offset:26624
    s_add_u32 m0, s65, 108544
    s_add_u32 s66, s66, 16384
    buffer_load_dwordx4 v50, s[24:27], s66 offen offset:0 lds
    v_cvt_pk_bf16_f32 v184, v168, v169
    v_cvt_pk_bf16_f32 v185, v170, v171
    v_mfma_f32_32x32x16_bf16 v[128:143], v[220:223], a[68:71], v[128:143]
    ds_read_b64_tr_b16 v[202:203], v80 offset:27648
    buffer_load_dwordx4 v51, s[24:27], s66 offen offset:1024 lds
    v_lshlrev_b32 v168, 16, v184
    v_mfma_f32_32x32x16_bf16 v[112:127], v[216:219], a[196:199], v[112:127]
    ds_read_b64_tr_b16 v[204:205], v81 offset:26624
    v_and_b32 v169, s79, v184
    v_lshlrev_b32 v170, 16, v185
    v_mfma_f32_32x32x16_bf16 v[144:159], v[220:223], a[196:199], v[144:159]
    ds_read_b64_tr_b16 v[206:207], v81 offset:27648
    v_and_b32 v171, s79, v185
    v_mul_f32 v168, v168, v91
    s_waitcnt vmcnt(15) lgkmcnt(3)
    v_mfma_f32_32x32x16_bf16 v[96:111], v[192:195], a[8:11], v[96:111]
    ds_read_b64_tr_b16 v[208:209], v80 offset:40960
    s_add_u32 s88, s23, 4096
    buffer_load_dwordx4 a[20:23], v17, s[8:11], s88 offen offset:0 sc1
    v_mul_f32 v169, v169, v91
    v_mul_f32 v170, v170, v91
    v_mfma_f32_32x32x16_bf16 v[128:143], v[196:199], a[8:11], v[128:143]
    ds_read_b64_tr_b16 v[210:211], v80 offset:41984
    buffer_load_dwordx4 a[148:151], v17, s[8:11], s88 offen offset:1024 sc1
    v_mul_f32 v171, v171, v91
    s_waitcnt vmcnt(16)
    v_mfma_f32_32x32x16_bf16 v[112:127], v[192:195], a[136:139], v[112:127]
    ds_read_b64_tr_b16 v[212:213], v81 offset:40960
    buffer_load_dword v10, v8, s[56:59], 0 offen offset:384 sc1
    v_cvt_pk_bf16_f32 v184, v168, v169
    v_cvt_pk_bf16_f32 v185, v170, v171
    v_mfma_f32_32x32x16_bf16 v[144:159], v[196:199], a[136:139], v[144:159]
    ds_read_b64_tr_b16 v[214:215], v81 offset:41984
    v_lshlrev_b32 v168, 16, v184
    v_and_b32 v169, s79, v184
    s_waitcnt vmcnt(16) lgkmcnt(3)
    v_mfma_f32_32x32x16_bf16 v[96:111], v[200:203], a[72:75], v[96:111]
    ds_read_b64_tr_b16 v[216:217], v80 offset:43008
    buffer_load_dwordx4 a[84:87], v17, s[8:11], s88 offen offset:2048 sc1
    v_lshlrev_b32 v170, 16, v185
    v_and_b32 v171, s79, v185
    v_mfma_f32_32x32x16_bf16 v[128:143], v[204:207], a[72:75], v[128:143]
    ds_read_b64_tr_b16 v[218:219], v80 offset:44032
    buffer_load_dwordx4 a[212:215], v17, s[8:11], s88 offen offset:3072 sc1
    v_mul_f32 v168, v168, v176
    v_mul_f32 v169, v169, v177
    s_waitcnt vmcnt(17)
    v_mfma_f32_32x32x16_bf16 v[112:127], v[200:203], a[200:203], v[112:127]
    ds_read_b64_tr_b16 v[220:221], v81 offset:43008
    s_lshl_b32 s66, s33, 3
    s_add_u32 s66, s66, s85
    s_add_u32 m0, s65, 0
    s_add_u32 s66, s66, 32768
    buffer_load_dwordx4 v50, s[24:27], s66 offen offset:0 lds
    v_mul_f32 v170, v170, v178
    v_mul_f32 v171, v171, v179
    v_mfma_f32_32x32x16_bf16 v[144:159], v[204:207], a[200:203], v[144:159]
    ds_read_b64_tr_b16 v[222:223], v81 offset:44032
    buffer_load_dwordx4 v51, s[24:27], s66 offen offset:1024 lds
    v_cvt_pk_bf16_f32 v184, v168, v169
    s_waitcnt vmcnt(18) lgkmcnt(3)
    v_mfma_f32_32x32x16_bf16 v[96:111], v[208:211], a[12:15], v[96:111]
    ds_read_b64_tr_b16 v[192:193], v82 offset:8192
    s_add_u32 m0, s65, 2048
    s_add_u32 s66, s66, 16384
    buffer_load_dwordx4 v50, s[24:27], s66 offen offset:0 lds
    v_cvt_pk_bf16_f32 v185, v170, v171
    v_mfma_f32_32x32x16_bf16 v[128:143], v[212:215], a[12:15], v[128:143]
    ds_read_b64_tr_b16 v[194:195], v82 offset:9216
    buffer_load_dwordx4 v51, s[24:27], s66 offen offset:1024 lds
    v_lshlrev_b32 v168, 16, v184
    v_and_b32 v169, s79, v184
    s_waitcnt vmcnt(19)
    v_mfma_f32_32x32x16_bf16 v[112:127], v[208:211], a[140:143], v[112:127]
    ds_read_b64_tr_b16 v[196:197], v83 offset:8192
    s_add_u32 s88, s32, 4096
    buffer_load_dwordx4 a[24:27], v17, s[8:11], s88 offen offset:0 sc1
    v_lshlrev_b32 v170, 16, v185
    v_and_b32 v171, s79, v185
    v_mfma_f32_32x32x16_bf16 v[144:159], v[212:215], a[140:143], v[144:159]
    ds_read_b64_tr_b16 v[198:199], v83 offset:9216
    buffer_load_dwordx4 a[152:155], v17, s[8:11], s88 offen offset:1024 sc1
    v_add_f32 v168, v168, v180
    v_add_f32 v169, v169, v181
    s_waitcnt vmcnt(20) lgkmcnt(3)
    v_mfma_f32_32x32x16_bf16 v[96:111], v[216:219], a[76:79], v[96:111]
    ds_read_b64_tr_b16 v[200:201], v82 offset:10240
    buffer_load_dwordx4 a[96:99], v17, s[8:11], s88 offen offset:2048 sc1
    v_add_f32 v170, v170, v182
    v_add_f32 v171, v171, v183
    v_mfma_f32_32x32x16_bf16 v[128:143], v[220:223], a[76:79], v[128:143]
    ds_read_b64_tr_b16 v[202:203], v82 offset:11264
    buffer_load_dwordx4 a[224:227], v17, s[8:11], s88 offen offset:3072 sc1
    v_mov_b32_dpp v90, v86 quad_perm:[3,3,3,3] row_mask:0xf bank_mask:0xf
    v_mov_b32_dpp v91, v88 quad_perm:[3,3,3,3] row_mask:0xf bank_mask:0xf
    s_waitcnt vmcnt(21)
    v_mfma_f32_32x32x16_bf16 v[112:127], v[216:219], a[204:207], v[112:127]
    ds_read_b64_tr_b16 v[204:205], v83 offset:10240
    s_lshl_b32 s66, s87, 3
    s_add_u32 s66, s66, s85
    s_add_u32 m0, s65, 147456
    s_add_u32 s66, s66, 0
    buffer_load_dwordx4 v50, s[24:27], s66 offen offset:0 lds
    v_lshlrev_b32 v180, 16, v30
    v_mfma_f32_32x32x16_bf16 v[144:159], v[220:223], a[204:207], v[144:159]
    ds_read_b64_tr_b16 v[206:207], v83 offset:11264
    buffer_load_dwordx4 v51, s[24:27], s66 offen offset:1024 lds
    v_and_b32 v181, s79, v30
    v_lshlrev_b32 v182, 16, v31
    s_waitcnt vmcnt(22) lgkmcnt(3)
    v_mfma_f32_32x32x16_bf16 v[96:111], v[192:195], a[16:19], v[96:111]
    ds_read_b64_tr_b16 v[208:209], v82 offset:24576
    s_add_u32 m0, s65, 149504
    s_add_u32 s66, s66, 16384
    buffer_load_dwordx4 v50, s[24:27], s66 offen offset:0 lds
    v_and_b32 v183, s79, v31
    v_sub_f32 v172, v180, v90
    v_mfma_f32_32x32x16_bf16 v[128:143], v[196:199], a[16:19], v[128:143]
    ds_read_b64_tr_b16 v[210:211], v82 offset:25600
    buffer_load_dwordx4 v51, s[24:27], s66 offen offset:1024 lds
    v_sub_f32 v173, v181, v90
    v_sub_f32 v174, v182, v90
    s_waitcnt vmcnt(23)
    v_mfma_f32_32x32x16_bf16 v[112:127], v[192:195], a[144:147], v[112:127]
    ds_read_b64_tr_b16 v[212:213], v83 offset:24576
parallel_sum__ssm_conv_s5__glu_gated_bilinear__prompt_kernel_chkG2:
    s_waitcnt vmcnt(14)
    v_cmp_ne_u32 s[100:101], s71, v10
    s_nop 1
    s_and_b32 s100, s100, s73
    s_cbranch_scc1 parallel_sum__ssm_conv_s5__glu_gated_bilinear__prompt_kernel_slowG2
parallel_sum__ssm_conv_s5__glu_gated_bilinear__prompt_kernel_goG2:
    v_sub_f32 v175, v183, v90
    v_mfma_f32_32x32x16_bf16 v[144:159], v[196:199], a[144:147], v[144:159]
    ds_read_b64_tr_b16 v[214:215], v83 offset:25600
    s_add_u32 s88, s33, 4096
    buffer_load_dwordx4 a[28:31], v17, s[8:11], s88 offen offset:0 sc1
    v_cvt_pk_bf16_f32 v184, v172, v173
    v_cvt_pk_bf16_f32 v185, v174, v175
    s_waitcnt lgkmcnt(3)
    v_mfma_f32_32x32x16_bf16 v[96:111], v[200:203], a[80:83], v[96:111]
    ds_read_b64_tr_b16 v[216:217], v82 offset:26624
    buffer_load_dwordx4 a[156:159], v17, s[8:11], s88 offen offset:1024 sc1
    v_lshlrev_b32 v172, 16, v184
    v_and_b32 v173, s79, v184
    v_mfma_f32_32x32x16_bf16 v[128:143], v[204:207], a[80:83], v[128:143]
    ds_read_b64_tr_b16 v[218:219], v82 offset:27648
    buffer_load_dwordx4 a[100:103], v17, s[8:11], s88 offen offset:2048 sc1
    v_lshlrev_b32 v174, 16, v185
    v_and_b32 v175, s79, v185
    v_mfma_f32_32x32x16_bf16 v[112:127], v[200:203], a[208:211], v[112:127]
    ds_read_b64_tr_b16 v[220:221], v83 offset:26624
    buffer_load_dwordx4 a[228:231], v17, s[8:11], s88 offen offset:3072 sc1
    v_mul_f32 v172, v172, v91
    v_mul_f32 v173, v173, v91
    v_mfma_f32_32x32x16_bf16 v[144:159], v[204:207], a[208:211], v[144:159]
    ds_read_b64_tr_b16 v[222:223], v83 offset:27648
    s_lshl_b32 s66, s92, 3
    s_add_u32 s66, s66, s85
    s_add_u32 m0, s65, 57344
    s_add_u32 s66, s66, 0
    buffer_load_dwordx4 v50, s[24:27], s66 offen offset:0 lds
    v_mul_f32 v174, v174, v91
    v_mul_f32 v175, v175, v91
    s_waitcnt lgkmcnt(3)
    v_mfma_f32_32x32x16_bf16 v[96:111], v[208:211], a[20:23], v[96:111]
    ds_read_b64_tr_b16 v[192:193], v82 offset:40960
    buffer_load_dwordx4 v51, s[24:27], s66 offen offset:1024 lds
    v_cvt_pk_bf16_f32 v184, v172, v173
    v_mfma_f32_32x32x16_bf16 v[128:143], v[212:215], a[20:23], v[128:143]
    ds_read_b64_tr_b16 v[194:195], v82 offset:41984
    s_add_u32 m0, s65, 59392
    s_add_u32 s66, s66, 16384
    buffer_load_dwordx4 v50, s[24:27], s66 offen offset:0 lds
    v_cvt_pk_bf16_f32 v185, v174, v175
    v_mfma_f32_32x32x16_bf16 v[112:127], v[208:211], a[148:151], v[112:127]
    ds_read_b64_tr_b16 v[196:197], v83 offset:40960
    buffer_load_dwordx4 v51, s[24:27], s66 offen offset:1024 lds
    v_lshlrev_b32 v172, 16, v184
    v_and_b32 v173, s79, v184
    v_mfma_f32_32x32x16_bf16 v[144:159], v[212:215], a[148:151], v[144:159]
    ds_read_b64_tr_b16 v[198:199], v83 offset:41984
    s_add_u32 s88, s87, 0
    buffer_load_dwordx4 a[32:35], v17, s[8:11], s88 offen offset:0 sc1
    v_lshlrev_b32 v174, 16, v185
    v_and_b32 v175, s79, v185
    s_waitcnt vmcnt(22) lgkmcnt(3)
    v_mfma_f32_32x32x16_bf16 v[96:111], v[216:219], a[84:87], v[96:111]
    ds_read_b64_tr_b16 v[200:201], v82 offset:43008
    buffer_load_dwordx4 a[160:163], v17, s[8:11], s88 offen offset:1024 sc1
    v_mul_f32 v172, v172, v176
    v_mul_f32 v173, v173, v177
    v_mfma_f32_32x32x16_bf16 v[128:143], v[220:223], a[84:87], v[128:143]
    ds_read_b64_tr_b16 v[202:203], v82 offset:44032
    buffer_load_dwordx4 a[112:115], v17, s[8:11], s88 offen offset:2048 sc1
    v_mul_f32 v174, v174, v178
    v_mul_f32 v175, v175, v179
    s_waitcnt vmcnt(23)
    v_mfma_f32_32x32x16_bf16 v[112:127], v[216:219], a[212:215], v[112:127]
    ds_read_b64_tr_b16 v[204:205], v83 offset:43008
    buffer_load_dwordx4 a[240:243], v17, s[8:11], s88 offen offset:3072 sc1
    v_cvt_pk_bf16_f32 v184, v172, v173
    v_cvt_pk_bf16_f32 v185, v174, v175
    v_mfma_f32_32x32x16_bf16 v[144:159], v[220:223], a[212:215], v[144:159]
    ds_read_b64_tr_b16 v[206:207], v83 offset:44032
    s_lshl_b32 s66, s5, 3
    s_add_u32 s66, s66, s85
    s_add_u32 m0, s65, 24576
    s_add_u32 s66, s66, 0
    buffer_load_dwordx4 v50, s[24:27], s66 offen offset:0 lds
    v_lshlrev_b32 v172, 16, v184
    s_waitcnt vmcnt(20) lgkmcnt(3)
    v_mfma_f32_32x32x16_bf16 v[96:111], v[192:195], a[24:27], v[96:111]
    ds_read_b64_tr_b16 v[208:209], v80 offset:0
    buffer_load_dwordx4 v51, s[24:27], s66 offen offset:1024 lds
    v_and_b32 v173, s79, v184
    v_lshlrev_b32 v174, 16, v185
    v_mfma_f32_32x32x16_bf16 v[128:143], v[196:199], a[24:27], v[128:143]
    ds_read_b64_tr_b16 v[210:211], v80 offset:1024
    s_add_u32 m0, s65, 26624
    s_add_u32 s66, s66, 16384
    buffer_load_dwordx4 v50, s[24:27], s66 offen offset:0 lds
    v_and_b32 v175, s79, v185
    v_add_f32 v172, v172, v180
    s_waitcnt vmcnt(21)
    v_mfma_f32_32x32x16_bf16 v[112:127], v[192:195], a[152:155], v[112:127]
    ds_read_b64_tr_b16 v[212:213], v81 offset:0
    buffer_load_dwordx4 v51, s[24:27], s66 offen offset:1024 lds
    v_add_f32 v173, v173, v181
    v_add_f32 v174, v174, v182
    v_mfma_f32_32x32x16_bf16 v[144:159], v[196:199], a[152:155], v[144:159]
    ds_read_b64_tr_b16 v[214:215], v81 offset:1024
    s_add_u32 s88, s92, 0
    buffer_load_dwordx4 a[36:39], v17, s[8:11], s88 offen offset:0 sc1
    v_add_f32 v175, v175, v183
    s_waitcnt vmcnt(22) lgkmcnt(3)
    v_mfma_f32_32x32x16_bf16 v[96:111], v[200:203], a[96:99], v[96:111]
    ds_read_b64_tr_b16 v[216:217], v80 offset:2048
    buffer_load_dwordx4 a[164:167], v17, s[8:11], s88 offen offset:1024 sc1
    v_and_b32 v2, 31, v1
    v_lshrrev_b32 v3, 5, v1
    v_mfma_f32_32x32x16_bf16 v[128:143], v[204:207], a[96:99], v[128:143]
    ds_read_b64_tr_b16 v[218:219], v80 offset:3072
    buffer_load_dwordx4 a[116:119], v17, s[8:11], s88 offen offset:2048 sc1
    v_and_b32 v6, 7, v2
    v_xor_b32 v3, v3, v6
    s_waitcnt vmcnt(23)
    v_mfma_f32_32x32x16_bf16 v[112:127], v[200:203], a[224:227], v[112:127]
    ds_read_b64_tr_b16 v[220:221], v81 offset:2048
    buffer_load_dwordx4 a[244:247], v17, s[8:11], s88 offen offset:3072 sc1
    v_lshlrev_b32 v3, 4, v3
    v_lshl_add_u32 v3, v2, 7, v3
    v_mfma_f32_32x32x16_bf16 v[144:159], v[204:207], a[224:227], v[144:159]
    ds_read_b64_tr_b16 v[222:223], v81 offset:3072
    s_add_u32 s88, s5, 0
    buffer_load_dwordx4 a[40:43], v17, s[8:11], s88 offen offset:0 sc1
    s_add_u32 s19, s65, 73728
    v_add_u32 v238, s19, v3
    s_waitcnt vmcnt(20) lgkmcnt(3)
    v_mfma_f32_32x32x16_bf16 v[96:111], v[208:211], a[28:31], v[96:111]
    ds_read_b64_tr_b16 v[192:193], v84 offset:16384
    buffer_load_dwordx4 a[168:171], v17, s[8:11], s88 offen offset:1024 sc1
    v_xor_b32 v239, 32, v238
    v_mfma_f32_32x32x16_bf16 v[128:143], v[212:215], a[28:31], v[128:143]
    ds_read_b64_tr_b16 v[194:195], v84 offset:17408
    buffer_load_dwordx4 a[88:91], v17, s[8:11], s88 offen offset:2048 sc1
    v_xor_b32 v240, 64, v238
    v_xor_b32 v241, 96, v238
    s_waitcnt vmcnt(21)
    v_mfma_f32_32x32x16_bf16 v[112:127], v[208:211], a[156:159], v[112:127]
    ds_read_b64_tr_b16 v[196:197], v85 offset:16384
    buffer_load_dwordx4 a[216:219], v17, s[8:11], s88 offen offset:3072 sc1
    v_lshrrev_b32 v2, 4, v1
    v_and_b32 v3, 7, v1
    v_mfma_f32_32x32x16_bf16 v[144:159], v[212:215], a[156:159], v[144:159]
    ds_read_b64_tr_b16 v[198:199], v85 offset:17408
    v_xor_b32 v3, v3, v2
    v_lshlrev_b32 v3, 4, v3
    s_waitcnt vmcnt(21) lgkmcnt(3)
    v_mfma_f32_32x32x16_bf16 v[96:111], v[216:219], a[100:103], v[96:111]
    ds_read_b64_tr_b16 v[200:201], v84 offset:18432
    v_lshl_add_u32 v3, v2, 7, v3
    v_bfe_u32 v2, v1, 3, 1
    v_mfma_f32_32x32x16_bf16 v[128:143], v[220:223], a[100:103], v[128:143]
    ds_read_b64_tr_b16 v[202:203], v84 offset:19456
    v_lshl_add_u32 v3, v2, 15, v3
    s_waitcnt vmcnt(20)
    v_mfma_f32_32x32x16_bf16 v[112:127], v[216:219], a[228:231], v[112:127]
    ds_read_b64_tr_b16 v[204:205], v85 offset:18432
    s_lshl_b32 s19, s60, 10
    s_add_u32 s19, s19, 73728
    v_add_u32 v242, s19, v3
    v_mfma_f32_32x32x16_bf16 v[144:159], v[220:223], a[228:231], v[144:159]
    ds_read_b64_tr_b16 v[206:207], v85 offset:19456
    v_xor_b32 v243, 64, v242
    s_waitcnt vmcnt(15) lgkmcnt(3)
    v_mfma_f32_32x32x16_bf16 v[96:111], v[192:195], a[32:35], v[96:111]
    ds_read_b64_tr_b16 v[208:209], v80 offset:57344
    s_lshl_b32 s19, s80, 3
    s_add_u32 s19, s19, s81
    s_mov_b32 s63, 2147483632
    s_cmp_eq_u32 s19, 248
    s_cselect_b32 s19, 10747904, s63
    v_mfma_f32_32x32x16_bf16 v[128:143], v[196:199], a[32:35], v[128:143]
    ds_read_b64_tr_b16 v[210:211], v80 offset:58368
    s_waitcnt vmcnt(14)
    v_mfma_f32_32x32x16_bf16 v[112:127], v[192:195], a[160:163], v[112:127]
    ds_read_b64_tr_b16 v[212:213], v81 offset:57344
    v_mov_b32 v2, s19
    v_mov_b32 v4, 2147483632
    v_cmp_eq_u32 vcc, 0, v0
    s_nop 1
    v_cndmask_b32 v2, v4, v2, vcc
    v_mfma_f32_32x32x16_bf16 v[144:159], v[196:199], a[160:163], v[144:159]
    ds_read_b64_tr_b16 v[214:215], v81 offset:58368
    s_waitcnt vmcnt(13) lgkmcnt(3)
    v_mfma_f32_32x32x16_bf16 v[96:111], v[200:203], a[112:115], v[96:111]
    ds_read_b64_tr_b16 v[216:217], v80 offset:59392
    s_waitcnt vmcnt(8)
    ds_read_b64_tr_b16 v[192:193], v80 offset:24576
    v_mfma_f32_32x32x16_bf16 v[128:143], v[204:207], a[112:115], v[128:143]
    ds_read_b64_tr_b16 v[218:219], v80 offset:60416
    ds_read_b64_tr_b16 v[194:195], v80 offset:25600
    v_mfma_f32_32x32x16_bf16 v[112:127], v[200:203], a[240:243], v[112:127]
    ds_read_b64_tr_b16 v[220:221], v81 offset:59392
    ds_read_b64_tr_b16 v[196:197], v81 offset:24576
    v_mfma_f32_32x32x16_bf16 v[144:159], v[204:207], a[240:243], v[144:159]
    ds_read_b64_tr_b16 v[222:223], v81 offset:60416
    ds_read_b64_tr_b16 v[198:199], v81 offset:25600
    s_waitcnt vmcnt(7) lgkmcnt(6)
    v_mfma_f32_32x32x16_bf16 v[96:111], v[208:211], a[36:39], v[96:111]
    ds_read_b64_tr_b16 v[200:201], v80 offset:26624
    ds_read_b64_tr_b16 v[202:203], v80 offset:27648
    s_waitcnt vmcnt(5) lgkmcnt(6)
    v_mfma_f32_32x32x16_bf16 v[96:111], v[216:219], a[116:119], v[96:111]
    ds_read_b64_tr_b16 v[204:205], v81 offset:26624
    ds_read_b64_tr_b16 v[206:207], v81 offset:27648
    s_waitcnt vmcnt(3)
    v_mfma_f32_32x32x16_bf16 v[96:111], v[192:195], a[40:43], v[96:111]
    s_waitcnt vmcnt(1) lgkmcnt(2)
    v_mfma_f32_32x32x16_bf16 v[96:111], v[200:203], a[88:91], v[96:111]
    v_mfma_f32_32x32x16_bf16 v[128:143], v[212:215], a[36:39], v[128:143]
    v_mfma_f32_32x32x16_bf16 v[128:143], v[220:223], a[116:119], v[128:143]
    v_mfma_f32_32x32x16_bf16 v[128:143], v[196:199], a[40:43], v[128:143]
    s_nop 8
    ds_write_b128 v238, v[96:99] offset:0
    s_waitcnt lgkmcnt(1)
    v_mfma_f32_32x32x16_bf16 v[128:143], v[204:207], a[88:91], v[128:143]
    ds_write_b128 v239, v[100:103] offset:0
    ds_write_b128 v240, v[104:107] offset:0
    v_mfma_f32_32x32x16_bf16 v[112:127], v[208:211], a[164:167], v[112:127]
    ds_write_b128 v241, v[108:111] offset:0
    v_mfma_f32_32x32x16_bf16 v[112:127], v[216:219], a[244:247], v[112:127]
    v_mfma_f32_32x32x16_bf16 v[112:127], v[192:195], a[168:171], v[112:127]
    s_nop 5
    ds_write_b128 v238, v[128:131] offset:32768
    ds_write_b128 v239, v[132:135] offset:32768
    s_waitcnt vmcnt(0)
    v_mfma_f32_32x32x16_bf16 v[112:127], v[200:203], a[216:219], v[112:127]
    ds_write_b128 v240, v[136:139] offset:32768
    ds_write_b128 v241, v[140:143] offset:32768
    v_mfma_f32_32x32x16_bf16 v[144:159], v[212:215], a[164:167], v[144:159]
    v_mfma_f32_32x32x16_bf16 v[144:159], v[220:223], a[244:247], v[144:159]
    s_waitcnt lgkmcnt(0)
    s_barrier
    ds_read_b128 v[96:99], v242 offset:0
    ds_read_b128 v[100:103], v242 offset:4096
    ds_read_b128 v[104:107], v242 offset:8192
    ds_read_b128 v[108:111], v242 offset:12288
    v_mfma_f32_32x32x16_bf16 v[144:159], v[196:199], a[168:171], v[144:159]
    ds_read_b128 v[128:131], v243 offset:512
    ds_read_b128 v[132:135], v243 offset:4608
    ds_read_b128 v[136:139], v243 offset:8704
    ds_read_b128 v[140:143], v243 offset:12800
    v_mfma_f32_32x32x16_bf16 v[144:159], v[204:207], a[216:219], v[144:159]
    ds_write_b128 v238, v[112:115] offset:16384
    ds_write_b128 v239, v[116:119] offset:16384
    ds_write_b128 v240, v[120:123] offset:16384
    ds_write_b128 v241, v[124:127] offset:16384
    s_waitcnt lgkmcnt(10)
    v_pk_add_f32 v[96:97], v[96:97], v[100:101]
    s_waitcnt lgkmcnt(8)
    v_pk_add_f32 v[104:105], v[104:105], v[108:109]
    v_pk_add_f32 v[98:99], v[98:99], v[102:103]
    v_pk_add_f32 v[106:107], v[106:107], v[110:111]
    v_pk_add_f32 v[96:97], v[96:97], v[160:161]
    v_pk_add_f32 v[98:99], v[98:99], v[162:163]
    v_pk_add_f32 v[96:97], v[96:97], v[104:105]
    v_pk_add_f32 v[98:99], v[98:99], v[106:107]
    global_store_dwordx4 v19, v[96:99], s[30:31] sc1
    ds_write_b128 v238, v[144:147] offset:49152
    ds_write_b128 v239, v[148:151] offset:49152
    ds_write_b128 v240, v[152:155] offset:49152
    ds_write_b128 v241, v[156:159] offset:49152
    s_waitcnt lgkmcnt(10)
    v_pk_add_f32 v[128:129], v[128:129], v[132:133]
    s_waitcnt lgkmcnt(8)
    v_pk_add_f32 v[136:137], v[136:137], v[140:141]
    v_pk_add_f32 v[130:131], v[130:131], v[134:135]
    v_pk_add_f32 v[138:139], v[138:139], v[142:143]
    v_pk_add_f32 v[128:129], v[128:129], v[164:165]
    v_pk_add_f32 v[130:131], v[130:131], v[166:167]
    v_pk_add_f32 v[128:129], v[128:129], v[136:137]
    v_pk_add_f32 v[130:131], v[130:131], v[138:139]
    v_add_u32 v19, 32768, v19
    global_store_dwordx4 v19, v[128:131], s[30:31] sc1
    s_waitcnt lgkmcnt(0)
    s_barrier
    ds_read_b128 v[112:115], v242 offset:16384
    ds_read_b128 v[116:119], v242 offset:20480
    ds_read_b128 v[120:123], v242 offset:24576
    ds_read_b128 v[124:127], v242 offset:28672
    ds_read_b128 v[144:147], v243 offset:16896
    ds_read_b128 v[148:151], v243 offset:20992
    ds_read_b128 v[152:155], v243 offset:25088
    ds_read_b128 v[156:159], v243 offset:29184
    buffer_store_dword v41, v2, s[56:59], 0 offen sc1
    s_waitcnt lgkmcnt(6)
    v_pk_add_f32 v[112:113], v[112:113], v[116:117]
    s_waitcnt lgkmcnt(4)
    v_pk_add_f32 v[120:121], v[120:121], v[124:125]
    v_pk_add_f32 v[114:115], v[114:115], v[118:119]
    v_pk_add_f32 v[122:123], v[122:123], v[126:127]
    v_pk_add_f32 v[112:113], v[112:113], v[168:169]
    v_pk_add_f32 v[114:115], v[114:115], v[170:171]
    v_pk_add_f32 v[112:113], v[112:113], v[120:121]
    v_pk_add_f32 v[114:115], v[114:115], v[122:123]
    v_add_u32 v19, 32768, v19
    global_store_dwordx4 v19, v[112:115], s[30:31] sc1
    s_waitcnt lgkmcnt(2)
    v_pk_add_f32 v[144:145], v[144:145], v[148:149]
    s_waitcnt lgkmcnt(0)
    v_pk_add_f32 v[152:153], v[152:153], v[156:157]
    v_pk_add_f32 v[146:147], v[146:147], v[150:151]
    v_pk_add_f32 v[154:155], v[154:155], v[158:159]
    v_pk_add_f32 v[144:145], v[144:145], v[172:173]
    v_pk_add_f32 v[146:147], v[146:147], v[174:175]
    v_pk_add_f32 v[144:145], v[144:145], v[152:153]
    v_pk_add_f32 v[146:147], v[146:147], v[154:155]
    v_add_u32 v19, 32768, v19
    global_store_dwordx4 v19, v[144:147], s[30:31] sc1
parallel_sum__ssm_conv_s5__glu_gated_bilinear__prompt_kernel_done:
    s_endpgm
parallel_sum__ssm_conv_s5__glu_gated_bilinear__prompt_kernel_slowT:
    buffer_load_dwordx4 v[248:251], v40, s[56:59], 0 offen sc1
    s_waitcnt vmcnt(0)
    s_sub_u32 s78, s78, 1
    s_cmp_lt_i32 s78, 1
    s_cbranch_scc1 parallel_sum__ssm_conv_s5__glu_gated_bilinear__prompt_kernel_goT
    s_branch parallel_sum__ssm_conv_s5__glu_gated_bilinear__prompt_kernel_chkT
parallel_sum__ssm_conv_s5__glu_gated_bilinear__prompt_kernel_slowA:
    buffer_load_dwordx4 v[8:11], v37, s[56:59], 0 offen sc1
    buffer_load_dwordx4 v[12:15], v37, s[56:59], s19 offen sc1
    s_waitcnt vmcnt(0)
    s_sub_u32 s78, s78, 1
    s_cmp_lt_i32 s78, 1
    s_cbranch_scc1 parallel_sum__ssm_conv_s5__glu_gated_bilinear__prompt_kernel_goA
    s_branch parallel_sum__ssm_conv_s5__glu_gated_bilinear__prompt_kernel_chkA
parallel_sum__ssm_conv_s5__glu_gated_bilinear__prompt_kernel_slowS:
    buffer_load_dword v9, v8, s[56:59], 0 offen sc1
    s_waitcnt vmcnt(0)
    s_sub_u32 s78, s78, 1
    s_cmp_lt_i32 s78, 1
    s_cbranch_scc1 parallel_sum__ssm_conv_s5__glu_gated_bilinear__prompt_kernel_goS
    s_branch parallel_sum__ssm_conv_s5__glu_gated_bilinear__prompt_kernel_chkS
parallel_sum__ssm_conv_s5__glu_gated_bilinear__prompt_kernel_slowG0:
    buffer_load_dword v10, v8, s[56:59], 0 offen offset:128 sc1
    s_waitcnt vmcnt(0)
    s_sub_u32 s78, s78, 1
    s_cmp_lt_i32 s78, 1
    s_cbranch_scc1 parallel_sum__ssm_conv_s5__glu_gated_bilinear__prompt_kernel_goG0
    s_branch parallel_sum__ssm_conv_s5__glu_gated_bilinear__prompt_kernel_chkG0
parallel_sum__ssm_conv_s5__glu_gated_bilinear__prompt_kernel_slowG1:
    buffer_load_dword v10, v8, s[56:59], 0 offen offset:256 sc1
    s_waitcnt vmcnt(0)
    s_sub_u32 s78, s78, 1
    s_cmp_lt_i32 s78, 1
    s_cbranch_scc1 parallel_sum__ssm_conv_s5__glu_gated_bilinear__prompt_kernel_goG1
    s_branch parallel_sum__ssm_conv_s5__glu_gated_bilinear__prompt_kernel_chkG1
parallel_sum__ssm_conv_s5__glu_gated_bilinear__prompt_kernel_slowG2:
    buffer_load_dword v10, v8, s[56:59], 0 offen offset:384 sc1
    s_waitcnt vmcnt(0)
    s_sub_u32 s78, s78, 1
    s_cmp_lt_i32 s78, 1
    s_cbranch_scc1 parallel_sum__ssm_conv_s5__glu_gated_bilinear__prompt_kernel_goG2
    s_branch parallel_sum__ssm_conv_s5__glu_gated_bilinear__prompt_kernel_chkG2
    .fill 256, 4, 0xbf810000
.section .rodata,"a"
.p2align 6
.amdhsa_kernel parallel_sum__ssm_conv_s5__glu_gated_bilinear__prompt_kernel
  .amdhsa_next_free_vgpr 512
  .amdhsa_next_free_sgpr 102
  .amdhsa_accum_offset 256
  .amdhsa_group_segment_fixed_size 0
  .amdhsa_kernarg_size 128
  .amdhsa_user_sgpr_count 2
  .amdhsa_user_sgpr_kernarg_segment_ptr 1
  .amdhsa_system_sgpr_workgroup_id_x 1
  .amdhsa_float_denorm_mode_32 3
.end_amdhsa_kernel
```
